```python
import torch

def _softmax(x, axis=-1):
    return torch.softmax(x, dim=axis)
def _gelu(x):
    return torch.nn.functional.gelu(x, approximate="tanh")
def _silu(x):
    return torch.nn.functional.silu(x)
def _sigmoid(x):
    return torch.sigmoid(x)
def _layernorm(x, axis=-1, eps=1e-5):
    m = x.mean(dim=axis, keepdim=True)
    v = x.var(dim=axis, keepdim=True, unbiased=False)
    return (x - m) / torch.sqrt(v + eps)
def _scatter_add(tgt, idx, src, axis=0):
    return tgt.clone().index_add_(axis, idx, src)
def _segment_sum(src, seg, n):
    out = torch.zeros((n,) + src.shape[1:], dtype=src.dtype)
    return out.index_add_(0, seg, src)
def _pad(x, pw):
    flat = tuple(v for pair in reversed(pw) for v in pair)
    return torch.nn.functional.pad(x, flat)

kernel_name = 'parallel_sum__sliding_block_cached__swiglu_ffn__decode'

def setup_inputs():

    _w = (lambda a: (lambda t: t.to(torch.bfloat16) if t.is_floating_point() else t)(torch.as_tensor(a)))
    def _A_setup():
        B, Sq, D = 1, 1, 576
        Hq, Hkv, Sk, Dh = 32, 16, 65536, 128
        assert Hq % Hkv == 0, (Hq, Hkv)
        return {
            "x": _w((lambda *s: torch.randn(*s, dtype=torch.bfloat16) * 0.05)(B, Sq, D)),
            "k_cache": _w((lambda *s: torch.randn(*s, dtype=torch.bfloat16) * 3.2)(B, Hkv, Sk, Dh)),
            "v_cache": _w((lambda *s: torch.randn(*s, dtype=torch.bfloat16) * 1.6)(B, Hkv, Sk, Dh)),
            "wq": _w((lambda *s: torch.randn(*s, dtype=torch.bfloat16) * 3.2)(D, Hq * Dh) * (D ** -0.5)),
            "wo": _w((lambda *s: torch.randn(*s, dtype=torch.bfloat16) * 1.6)(Hq * Dh, D) * ((Hq * Dh) ** -0.5)),
        }
    _A_in = _A_setup()

    def _B_setup():
        B, S, D, F = 1, 1, 576, 4608
        return {
            "x": _w((lambda *s: torch.randn(*s, dtype=torch.bfloat16) * 0.05)(B, S, D)),
            "w_gate": _w((lambda *s: torch.randn(*s, dtype=torch.bfloat16) * 0.05)(D, F)),
            "w_up": _w((lambda *s: torch.randn(*s, dtype=torch.bfloat16) * 0.05)(D, F)),
            "w_down": _w((lambda *s: torch.randn(*s, dtype=torch.bfloat16) * 0.05)(F, D)),
        }
    _B_in = _B_setup()

    return {
        "A_x": _A_in["x"],
        "A_k_cache": _A_in["k_cache"],
        "A_v_cache": _A_in["v_cache"],
        "A_wq": _A_in["wq"],
        "A_wo": _A_in["wo"],
        "B_x": _B_in["x"],
        "B_w_gate": _B_in["w_gate"],
        "B_w_up": _B_in["w_up"],
        "B_w_down": _B_in["w_down"],
    }

def reference(A_x, A_k_cache, A_v_cache, A_wq, A_wo, B_x, B_w_gate, B_w_up, B_w_down):
    def _A_ref(x, k_cache, v_cache, wq, wo):
        B, Sq, D = x.shape
        Hq, Dh = 32, 128
        Hkv, Sk = k_cache.shape[1], k_cache.shape[2]
        W = min(4096, max(256, Sk // 4))
        rep = Hq // Hkv
        q = (lambda x, *d: x.permute(*d))((x @ wq).reshape(B, Sq, Hq, Dh), 0, 2, 1, 3)
        k = (lambda x, n, axis: torch.repeat_interleave(x, n, dim=axis))(k_cache[:, :, Sk - W:, :], rep, axis=1)
        v = (lambda x, n, axis: torch.repeat_interleave(x, n, dim=axis))(v_cache[:, :, Sk - W:, :], rep, axis=1)
        scores = torch.einsum("bhqd,bhkd->bhqk", q, k) * (Dh ** -0.5)
        p = _softmax(scores, axis=-1)
        o = torch.einsum("bhqk,bhkd->bhqd", p, v)
        return (lambda x, *d: x.permute(*d))(o, 0, 2, 1, 3).reshape(B, Sq, Hq * Dh) @ wo

    def _B_ref(x, w_gate, w_up, w_down):
        g = _silu(x @ w_gate)
        u = x @ w_up
        return (g * u) @ w_down

    x = A_x
    xn = _layernorm(x, axis=-1)
    return x + _A_ref(xn, A_k_cache, A_v_cache, A_wq, A_wo) + _B_ref(xn, B_w_gate, B_w_up, B_w_down)
```

```asm
; @launch grid=(256,1,1) block=(768,1,1) lds=150528
.amdgcn_target "amdgcn-amd-amdhsa--gfx950"
.text
.globl parallel_sum__sliding_block_cached__swiglu_ffn__decode_kernel
.p2align 8
.type parallel_sum__sliding_block_cached__swiglu_ffn__decode_kernel,@function
parallel_sum__sliding_block_cached__swiglu_ffn__decode_kernel:
    s_cmp_ge_u32 s2, 256
    s_cbranch_scc1 L_end
    s_load_dwordx16 s[16:31], s[0:1], 0
    s_load_dwordx8 s[32:39], s[0:1], 64
    s_lshr_b32 s5, s2, 3
    s_and_b32 s7, s5, 15
    s_getpc_b64 s[10:11]
    s_lshl_b32 s12, s7, 7
    v_lshlrev_b32 v3, 11, v0
    v_add_u32 v3, s12, v3
    v_cmp_gt_u32 vcc, 6, v0
    s_and_saveexec_b64 s[12:13], vcc
    s_cbranch_execz L_nopf
    global_load_dword v139, v3, s[10:11] offset:384
L_nopf:
    s_mov_b64 exec, -1
    v_lshrrev_b32 v2, 6, v0
    v_and_b32 v1, 63, v0
    v_lshlrev_b32 v3, 2, v0
    v_mov_b32 v8, 0
    v_readfirstlane_b32 s3, v2
    v_add_u32 v3, 147456, v3
    v_lshlrev_b32 v5, 4, v1
    ds_write_b32 v3, v8
    s_and_b32 s4, s2, 7
    s_lshr_b32 s10, s5, 4
    s_lshl_b32 s6, s4, 1
    s_add_u32 s6, s6, s10
    s_mov_b32 s56, 0x200000
    v_lshrrev_b32 v6, 3, v1
    v_and_b32 v7, 0x70, v5
    s_xor_b32 s11, s3, 4
    s_cmp_lt_u32 s3, 8
    s_cselect_b32 s3, s11, s3
    s_sub_u32 s10, s3, 4
    s_lshl_b32 s12, s10, 13
    v_mul_u32_u24 v12, 147456, v6
    v_add3_u32 v12, v12, v7, s12
    s_lshl_b32 s13, s6, 9
    s_and_b32 s14, s7, 3
    s_lshl_b32 s14, s14, 7
    s_add_u32 s13, s13, s14
    s_lshr_b32 s15, s7, 2
    s_mul_i32 s14, s15, 1179648
    s_add_u32 s13, s13, s14
    s_mov_b32 s42, 1179648
    s_mov_b32 s43, 0x20000
    s_lshl_b32 s12, s10, 10
    s_waitcnt lgkmcnt(0)
    s_cmp_lt_u32 s10, 4
    s_cbranch_scc1 L_L
    s_cmp_gt_u32 s3, 8
    s_cbranch_scc1 L_bar
    global_load_dword v21, v8, s[38:39] sc1
    s_cmp_eq_u32 s3, 8
    s_cbranch_scc1 L_bar
    v_and_b32 v13, 31, v1
    v_lshlrev_b32 v13, 2, v13
    global_load_dwordx4 v[16:19], v5, s[16:17]
    global_load_dword v20, v13, s[16:17] offset:1024
L_bar:
    s_barrier
    s_branch L_notL
L_L:
    s_add_u32 s40, s22, s13
    s_addc_u32 s41, s23, 0
    s_add_u32 m0, s12, 114688
    s_mov_b32 s11, 0
    buffer_load_dwordx4 v12, s[40:43], s11 offen nt lds
    s_addk_i32 m0, 4096
    s_mov_b32 s11, 32768
    buffer_load_dwordx4 v12, s[40:43], s11 offen nt lds
    s_addk_i32 m0, 4096
    s_mov_b32 s11, 65536
    buffer_load_dwordx4 v12, s[40:43], s11 offen nt lds
    s_addk_i32 m0, 4096
    s_mov_b32 s11, 98304
    buffer_load_dwordx4 v12, s[40:43], s11 offen nt lds
    s_cmp_ge_u32 s10, 2
    s_cbranch_scc1 L_s1
    s_add_u32 m0, s12, 131072
    s_mov_b32 s11, 131072
    buffer_load_dwordx4 v12, s[40:43], s11 offen nt lds
L_s1:
    s_barrier
    s_mul_i32 s59, s7, 21846
    s_lshr_b32 s59, s59, 16
    s_mul_i32 s57, s59, 3
    s_sub_u32 s57, s7, s57
    s_lshr_b32 s11, s5, 4
    s_mul_i32 s11, s11, 5
    s_add_u32 s8, s59, s11
    s_mul_i32 s11, s4, 9
    s_add_u32 s8, s8, s11
    s_lshr_b32 s58, 0x0fff7fff, s5
    s_and_b32 s58, s58, 1
    s_mul_i32 s13, s57, 1769472
    s_lshl_b32 s14, s8, 7
    s_add_u32 s13, s13, s14
    s_add_u32 s44, s28, s13
    s_addc_u32 s45, s29, 0
    s_mov_b32 s46, 1760384
    s_mov_b32 s47, 0x20000
    s_add_u32 s48, s30, s13
    s_addc_u32 s49, s31, 0
    s_mov_b32 s50, 1760384
    s_mov_b32 s51, 0x20000
    s_cmp_eq_u32 s58, 1
    s_cselect_b32 s46, s46, 0
    s_cselect_b32 s50, s50, 0
    s_mul_i32 s14, s10, 9216
    v_mul_u32_u24 v13, 73728, v6
    v_add3_u32 v13, v13, v7, s14
    s_bfe_u32 s89, s44, 0x30007
    s_mul_i32 s89, s89, s58
    s_cmp_eq_u32 s89, 3
    s_cselect_b64 s[90:91], -1, 0
    s_mov_b64 vcc, s[90:91]
    v_mov_b32 v2, 147456
    v_mov_b32 v3, 1
    s_add_u32 m0, s12, 65536
    s_mov_b32 s11, 0
    buffer_load_dwordx4 v13, s[44:47], s11 offen nt lds
    s_waitcnt vmcnt(7)
    s_cbranch_vccnz L_a2
    s_waitcnt vmcnt(5)
L_a2:
    s_addk_i32 m0, 4096
    s_mov_b32 s11, 36864
    buffer_load_dwordx4 v13, s[44:47], s11 offen nt lds
    s_waitcnt vmcnt(7)
    s_cbranch_vccnz L_a3
    s_waitcnt vmcnt(5)
L_a3:
    s_addk_i32 m0, 4096
    s_mov_b32 s11, 0
    buffer_load_dwordx4 v13, s[48:51], s11 offen nt lds
    v_and_b32 v10, 15, v1
    v_lshrrev_b32 v11, 4, v1
    s_lshl_b32 s14, s10, 2
    v_add_u32 v11, s14, v11
    v_xor_b32 v14, v10, v11
    v_lshlrev_b32 v14, 4, v14
    v_lshl_add_u32 v14, v11, 8, v14
    v_and_b32 v15, 7, v11
    v_lshlrev_b32 v15, 1, v15
    v_xor_b32 v15, v10, v15
    v_lshlrev_b32 v15, 4, v15
    v_lshl_add_u32 v15, v11, 8, v15
    s_add_u32 s83, s6, s7
    s_lshl_b32 s83, s83, 12
    s_and_b32 s83, s83, 0xffff
    s_lshl_b32 s13, s6, 24
    s_lshl_b32 s14, s7, 16
    s_add_u32 s13, s13, s14
    s_add_u32 s13, s13, 15728640
    s_add_u32 s52, s18, s13
    s_addc_u32 s53, s19, 0
    s_mov_b32 s54, 65536
    s_mov_b32 s55, 0x20000
    s_add_u32 s60, s20, s13
    s_addc_u32 s61, s21, 0
    s_mov_b32 s62, 65536
    s_mov_b32 s63, 0x20000
    s_mul_i32 s15, s57, 384
    s_lshl_b32 s13, s6, 4
    s_add_u32 s13, s13, s59
    s_mul_i32 s13, s13, 18432
    s_add_u32 s13, s13, s15
    s_add_u32 s68, s24, s13
    s_addc_u32 s69, s25, 0
    s_mov_b32 s70, 0
    s_mov_b32 s71, 0x20000
    s_mul_i32 s14, s59, 18432
    s_sub_u32 s14, 294144, s14
    s_cmp_lt_u32 s7, 15
    s_cselect_b32 s70, s14, 0
    s_mul_i32 s13, s8, 73728
    s_add_u32 s13, s13, s15
    s_add_u32 s64, s32, s13
    s_addc_u32 s65, s33, 0
    s_mov_b32 s66, 72960
    s_mov_b32 s67, 0x20000
    s_cmp_eq_u32 s58, 1
    s_cselect_b32 s66, s66, 0
    s_mul_i32 s13, s10, 18432
    s_mul_i32 s14, s10, 92160
    s_mov_b32 s15, 0xaaaaaab
    v_add_u32 v10, 0, v1
    v_mul_hi_u32 v11, v10, s15
    v_and_b32 v9, 6, v11
    v_mul_u32_u24 v8, 24, v11
    v_sub_u32 v10, v10, v8
    v_xor_b32 v10, v10, v9
    v_mul_u32_u24 v11, 1152, v11
    v_lshl_add_u32 v11, v10, 4, v11
    v_add_u32 v16, s13, v11
    v_add_u32 v19, s14, v11
    v_add_u32 v10, 64, v1
    v_mul_hi_u32 v11, v10, s15
    v_and_b32 v9, 6, v11
    v_mul_u32_u24 v8, 24, v11
    v_sub_u32 v10, v10, v8
    v_xor_b32 v10, v10, v9
    v_mul_u32_u24 v11, 1152, v11
    v_lshl_add_u32 v11, v10, 4, v11
    v_add_u32 v17, s13, v11
    v_add_u32 v20, s14, v11
    v_add_u32 v10, 128, v1
    v_mul_hi_u32 v11, v10, s15
    v_and_b32 v9, 6, v11
    v_mul_u32_u24 v8, 24, v11
    v_sub_u32 v10, v10, v8
    v_xor_b32 v10, v10, v9
    v_mul_u32_u24 v11, 1152, v11
    v_lshl_add_u32 v11, v10, 4, v11
    v_add_u32 v18, s13, v11
    v_add_u32 v21, s14, v11
    s_mul_i32 s15, s10, 6144
    s_waitcnt vmcnt(7)
    s_cbranch_vccnz L_a4
    s_waitcnt vmcnt(5)
L_a4:
    s_mov_b32 m0, s12
    s_mov_b32 s11, s83
    buffer_load_dwordx4 v14, s[52:55], s11 offen nt lds
    s_waitcnt vmcnt(7)
    s_cbranch_vccnz L_a5
    s_waitcnt vmcnt(5)
L_a5:
    s_add_u32 m0, s12, 77824
    s_mov_b32 s11, 36864
    buffer_load_dwordx4 v13, s[48:51], s11 offen nt lds
    s_waitcnt vmcnt(5)
    s_mov_b64 exec, 1
    ds_add_u32 v2, v3 offset:0
    s_mov_b64 exec, -1
    s_addk_i32 m0, 4096
    s_mov_b32 s11, 589824
    buffer_load_dwordx4 v13, s[44:47], s11 offen nt lds
    s_waitcnt vmcnt(7)
    s_cbranch_vccnz L_a6
    s_waitcnt vmcnt(5)
L_a6:
    s_addk_i32 m0, 4096
    s_mov_b32 s11, 626688
    buffer_load_dwordx4 v13, s[44:47], s11 offen nt lds
    s_waitcnt vmcnt(7)
    s_cbranch_vccnz L_a7
    s_waitcnt vmcnt(5)
L_a7:
    s_add_u32 m0, s12, 4096
    s_add_u32 s11, s83, 4096
    s_and_b32 s11, s11, 65535
    buffer_load_dwordx4 v14, s[52:55], s11 offen nt lds
    s_waitcnt vmcnt(7)
    s_cbranch_vccnz L_a8
    s_waitcnt vmcnt(5)
L_a8:
    s_add_u32 m0, s12, 90112
    s_mov_b32 s11, 589824
    buffer_load_dwordx4 v13, s[48:51], s11 offen nt lds
    s_waitcnt vmcnt(7)
    s_cbranch_vccnz L_a9
    s_waitcnt vmcnt(5)
L_a9:
    s_addk_i32 m0, 4096
    s_mov_b32 s11, 626688
    buffer_load_dwordx4 v13, s[48:51], s11 offen nt lds
    s_waitcnt vmcnt(7)
    s_cbranch_vccnz L_a10
    s_waitcnt vmcnt(5)
L_a10:
    s_addk_i32 m0, 4096
    s_mov_b32 s11, 1179648
    buffer_load_dwordx4 v13, s[44:47], s11 offen nt lds
    s_waitcnt vmcnt(7)
    s_cbranch_vccnz L_a11
    s_waitcnt vmcnt(5)
L_a11:
    s_add_u32 m0, s12, 8192
    s_add_u32 s11, s83, 8192
    s_and_b32 s11, s11, 65535
    buffer_load_dwordx4 v14, s[52:55], s11 offen nt lds
    s_waitcnt vmcnt(7)
    s_cbranch_vccnz L_a12
    s_waitcnt vmcnt(5)
L_a12:
    s_add_u32 m0, s12, 102400
    s_mov_b32 s11, 1216512
    buffer_load_dwordx4 v13, s[44:47], s11 offen nt lds
    s_waitcnt vmcnt(7)
    s_cbranch_vccnz L_a13
    s_waitcnt vmcnt(5)
L_a13:
    s_addk_i32 m0, 4096
    s_mov_b32 s11, 1179648
    buffer_load_dwordx4 v13, s[48:51], s11 offen nt lds
    s_waitcnt vmcnt(7)
    s_cbranch_vccnz L_a14
    s_waitcnt vmcnt(5)
L_a14:
    s_addk_i32 m0, 4096
    s_mov_b32 s11, 1216512
    buffer_load_dwordx4 v13, s[48:51], s11 offen nt lds
    s_waitcnt vmcnt(7)
    s_cbranch_vccnz L_a15
    s_waitcnt vmcnt(5)
L_a15:
    s_add_u32 m0, s12, 12288
    s_add_u32 s11, s83, 12288
    s_and_b32 s11, s11, 65535
    buffer_load_dwordx4 v14, s[52:55], s11 offen nt lds
    s_waitcnt vmcnt(7)
    s_cbranch_vccnz L_a16
    s_waitcnt vmcnt(5)
L_a16:
    s_addk_i32 m0, 4096
    s_addk_i32 s11, 0x1000
    s_and_b32 s11, s11, 0xffff
    buffer_load_dwordx4 v14, s[52:55], s11 offen nt lds
    s_waitcnt vmcnt(7)
    s_cbranch_vccnz L_a17
    s_waitcnt vmcnt(5)
L_a17:
    s_addk_i32 m0, 4096
    s_addk_i32 s11, 0x1000
    s_and_b32 s11, s11, 0xffff
    buffer_load_dwordx4 v14, s[52:55], s11 offen nt lds
    s_waitcnt vmcnt(7)
    s_cbranch_vccnz L_a18
    s_waitcnt vmcnt(5)
L_a18:
    s_addk_i32 m0, 4096
    s_addk_i32 s11, 0x1000
    s_and_b32 s11, s11, 0xffff
    buffer_load_dwordx4 v14, s[52:55], s11 offen nt lds
    s_waitcnt vmcnt(7)
    s_cbranch_vccnz L_a19
    s_waitcnt vmcnt(5)
L_a19:
    s_addk_i32 m0, 4096
    s_addk_i32 s11, 0x1000
    s_and_b32 s11, s11, 0xffff
    buffer_load_dwordx4 v14, s[52:55], s11 offen nt lds
    s_waitcnt vmcnt(5)
    s_mov_b64 exec, 1
    ds_add_u32 v2, v3 offset:4
    s_mov_b64 exec, -1
    s_addk_i32 m0, 4096
    s_addk_i32 s11, 0x1000
    s_and_b32 s11, s11, 0xffff
    buffer_load_dwordx4 v14, s[52:55], s11 offen nt lds
    s_waitcnt vmcnt(7)
    s_cbranch_vccnz L_a20
    s_waitcnt vmcnt(5)
L_a20:
    s_addk_i32 m0, 4096
    s_addk_i32 s11, 0x1000
    s_and_b32 s11, s11, 0xffff
    buffer_load_dwordx4 v14, s[52:55], s11 offen nt lds
    s_waitcnt vmcnt(7)
    s_cbranch_vccnz L_a21
    s_waitcnt vmcnt(5)
L_a21:
    s_addk_i32 m0, 4096
    s_addk_i32 s11, 0x1000
    s_and_b32 s11, s11, 0xffff
    buffer_load_dwordx4 v14, s[52:55], s11 offen nt lds
    s_waitcnt vmcnt(7)
    s_cbranch_vccnz L_a22
    s_waitcnt vmcnt(5)
L_a22:
    s_addk_i32 m0, 4096
    s_addk_i32 s11, 0x1000
    s_and_b32 s11, s11, 0xffff
    buffer_load_dwordx4 v14, s[52:55], s11 offen nt lds
    s_waitcnt vmcnt(7)
    s_cbranch_vccnz L_a23
    s_waitcnt vmcnt(5)
L_a23:
    s_addk_i32 m0, 4096
    s_addk_i32 s11, 0x1000
    s_and_b32 s11, s11, 0xffff
    buffer_load_dwordx4 v14, s[52:55], s11 offen nt lds
    s_waitcnt vmcnt(7)
    s_cbranch_vccnz L_a24
    s_waitcnt vmcnt(5)
L_a24:
    s_addk_i32 m0, 4096
    s_addk_i32 s11, 0x1000
    s_and_b32 s11, s11, 0xffff
    buffer_load_dwordx4 v14, s[52:55], s11 offen nt lds
    s_waitcnt vmcnt(7)
    s_cbranch_vccnz L_a25
    s_waitcnt vmcnt(5)
L_a25:
    s_addk_i32 m0, 4096
    s_addk_i32 s11, 0x1000
    s_and_b32 s11, s11, 0xffff
    buffer_load_dwordx4 v14, s[52:55], s11 offen nt lds
    s_waitcnt vmcnt(7)
    s_cbranch_vccnz L_a26
    s_waitcnt vmcnt(5)
L_a26:
    s_addk_i32 m0, 4096
    s_addk_i32 s11, 0x1000
    s_and_b32 s11, s11, 0xffff
    buffer_load_dwordx4 v14, s[52:55], s11 offen nt lds
    s_waitcnt vmcnt(7)
    s_cbranch_vccnz L_a27
    s_waitcnt vmcnt(5)
L_a27:
L_w28:
    ds_read_b32 v4, v2 offset:56
    s_waitcnt lgkmcnt(0)
    v_cmp_le_u32 vcc, 1, v4
    s_cbranch_vccnz L_d29
    s_sub_u32 s56, s56, 1
    s_cbranch_scc1 L_end
    s_sleep 1
    s_branch L_w28
L_d29:
L_w30:
    ds_read_b32 v4, v2 offset:80
    s_waitcnt lgkmcnt(0)
    v_cmp_le_u32 vcc, 3, v4
    s_cbranch_vccnz L_d31
    s_sub_u32 s56, s56, 1
    s_cbranch_scc1 L_end
    s_sleep 1
    s_branch L_w30
L_d31:
    s_mov_b64 vcc, s[90:91]
    s_mov_b64 vcc, s[90:91]
    s_add_u32 m0, s12, 65536
    s_mov_b32 s11, s83
    buffer_load_dwordx4 v15, s[60:63], s11 offen nt lds
    s_waitcnt vmcnt(7)
    s_cbranch_vccnz L_a32
    s_waitcnt vmcnt(5)
L_a32:
    s_addk_i32 m0, 4096
    s_addk_i32 s11, 0x1000
    s_and_b32 s11, s11, 0xffff
    buffer_load_dwordx4 v15, s[60:63], s11 offen nt lds
    s_waitcnt vmcnt(7)
    s_cbranch_vccnz L_a33
    s_waitcnt vmcnt(5)
L_a33:
    s_addk_i32 m0, 4096
    s_addk_i32 s11, 0x1000
    s_and_b32 s11, s11, 0xffff
    buffer_load_dwordx4 v15, s[60:63], s11 offen nt lds
    s_waitcnt vmcnt(7)
    s_cbranch_vccnz L_a34
    s_waitcnt vmcnt(5)
L_a34:
    s_addk_i32 m0, 4096
    s_addk_i32 s11, 0x1000
    s_and_b32 s11, s11, 0xffff
    buffer_load_dwordx4 v15, s[60:63], s11 offen nt lds
    s_waitcnt vmcnt(7)
    s_cbranch_vccnz L_a35
    s_waitcnt vmcnt(5)
L_a35:
    s_addk_i32 m0, 4096
    s_addk_i32 s11, 0x1000
    s_and_b32 s11, s11, 0xffff
    buffer_load_dwordx4 v15, s[60:63], s11 offen nt lds
    s_waitcnt vmcnt(5)
    s_mov_b64 exec, 1
    ds_add_u32 v2, v3 offset:8
    s_mov_b64 exec, -1
    s_addk_i32 m0, 4096
    s_addk_i32 s11, 0x1000
    s_and_b32 s11, s11, 0xffff
    buffer_load_dwordx4 v15, s[60:63], s11 offen nt lds
    s_waitcnt vmcnt(7)
    s_cbranch_vccnz L_a36
    s_waitcnt vmcnt(5)
L_a36:
    s_addk_i32 m0, 4096
    s_addk_i32 s11, 0x1000
    s_and_b32 s11, s11, 0xffff
    buffer_load_dwordx4 v15, s[60:63], s11 offen nt lds
    s_waitcnt vmcnt(7)
    s_cbranch_vccnz L_a37
    s_waitcnt vmcnt(5)
L_a37:
    s_addk_i32 m0, 4096
    s_addk_i32 s11, 0x1000
    s_and_b32 s11, s11, 0xffff
    buffer_load_dwordx4 v15, s[60:63], s11 offen nt lds
    s_waitcnt vmcnt(7)
    s_cbranch_vccnz L_a38
    s_waitcnt vmcnt(5)
L_a38:
    s_addk_i32 m0, 4096
    s_addk_i32 s11, 0x1000
    s_and_b32 s11, s11, 0xffff
    buffer_load_dwordx4 v15, s[60:63], s11 offen nt lds
    s_waitcnt vmcnt(7)
    s_cbranch_vccnz L_a39
    s_waitcnt vmcnt(5)
L_a39:
    s_addk_i32 m0, 4096
    s_addk_i32 s11, 0x1000
    s_and_b32 s11, s11, 0xffff
    buffer_load_dwordx4 v15, s[60:63], s11 offen nt lds
    s_waitcnt vmcnt(7)
    s_cbranch_vccnz L_a40
    s_waitcnt vmcnt(5)
L_a40:
    s_addk_i32 m0, 4096
    s_addk_i32 s11, 0x1000
    s_and_b32 s11, s11, 0xffff
    buffer_load_dwordx4 v15, s[60:63], s11 offen nt lds
    s_waitcnt vmcnt(7)
    s_cbranch_vccnz L_a41
    s_waitcnt vmcnt(5)
L_a41:
    s_addk_i32 m0, 4096
    s_addk_i32 s11, 0x1000
    s_and_b32 s11, s11, 0xffff
    buffer_load_dwordx4 v15, s[60:63], s11 offen nt lds
    s_waitcnt vmcnt(7)
    s_cbranch_vccnz L_a42
    s_waitcnt vmcnt(5)
L_a42:
    s_addk_i32 m0, 4096
    s_addk_i32 s11, 0x1000
    s_and_b32 s11, s11, 0xffff
    buffer_load_dwordx4 v15, s[60:63], s11 offen nt lds
    s_waitcnt vmcnt(5)
    s_mov_b64 exec, 1
    ds_add_u32 v2, v3 offset:24
    s_mov_b64 exec, -1
    s_addk_i32 m0, 4096
    s_addk_i32 s11, 0x1000
    s_and_b32 s11, s11, 0xffff
    buffer_load_dwordx4 v15, s[60:63], s11 offen nt lds
    s_waitcnt vmcnt(7)
    s_cbranch_vccnz L_a43
    s_waitcnt vmcnt(5)
L_a43:
    s_addk_i32 m0, 4096
    s_addk_i32 s11, 0x1000
    s_and_b32 s11, s11, 0xffff
    buffer_load_dwordx4 v15, s[60:63], s11 offen nt lds
    s_waitcnt vmcnt(7)
    s_cbranch_vccnz L_a44
    s_waitcnt vmcnt(5)
L_a44:
    s_addk_i32 m0, 4096
    s_addk_i32 s11, 0x1000
    s_and_b32 s11, s11, 0xffff
    buffer_load_dwordx4 v15, s[60:63], s11 offen nt lds
    s_waitcnt vmcnt(7)
    s_cbranch_vccnz L_a45
    s_waitcnt vmcnt(5)
L_a45:
L_w46:
    ds_read_b32 v4, v2 offset:12
    s_waitcnt lgkmcnt(0)
    v_cmp_le_u32 vcc, 4, v4
    s_cbranch_vccnz L_d47
    s_sub_u32 s56, s56, 1
    s_cbranch_scc1 L_end
    s_sleep 1
    s_branch L_w46
L_d47:
    s_mov_b64 vcc, s[90:91]
    s_mov_b32 m0, s15
    s_mov_b32 s11, 0
    buffer_load_dwordx4 v16, s[64:67], s11 offen nt lds
    s_waitcnt vmcnt(5)
    s_mov_b64 exec, 1
    ds_add_u32 v2, v3 offset:32
    s_mov_b64 exec, -1
    s_addk_i32 m0, 1024
    s_mov_b32 s11, 0
    buffer_load_dwordx4 v17, s[64:67], s11 offen nt lds
    s_waitcnt vmcnt(7)
    s_cbranch_vccnz L_a48
    s_waitcnt vmcnt(5)
L_a48:
    s_addk_i32 m0, 1024
    s_mov_b32 s11, 0
    buffer_load_dwordx4 v18, s[64:67], s11 offen nt lds
    s_waitcnt vmcnt(5)
    s_mov_b64 exec, 1
    ds_add_u32 v2, v3 offset:36
    s_mov_b64 exec, -1
    s_addk_i32 m0, 1024
    s_addk_i32 s11, 9216
    buffer_load_dwordx4 v16, s[64:67], s11 offen nt lds
    s_waitcnt vmcnt(7)
    s_cbranch_vccnz L_a49
    s_waitcnt vmcnt(5)
L_a49:
    s_addk_i32 m0, 1024
    s_mov_b32 s11, 9216
    buffer_load_dwordx4 v17, s[64:67], s11 offen nt lds
    s_waitcnt vmcnt(5)
    s_mov_b64 exec, 1
    ds_add_u32 v2, v3 offset:28
    s_mov_b64 exec, -1
    s_addk_i32 m0, 1024
    s_mov_b32 s11, 9216
    buffer_load_dwordx4 v18, s[64:67], s11 offen nt lds
    s_waitcnt vmcnt(7)
    s_cbranch_vccnz L_a50
    s_waitcnt vmcnt(5)
L_a50:
    s_add_u32 m0, s15, 24576
    s_mov_b32 s11, 0
    buffer_load_dwordx4 v19, s[68:71], s11 offen nt lds
    s_waitcnt vmcnt(7)
    s_cbranch_vccnz L_a51
    s_waitcnt vmcnt(5)
L_a51:
    s_addk_i32 m0, 1024
    s_mov_b32 s11, 0
    buffer_load_dwordx4 v20, s[68:71], s11 offen nt lds
    s_waitcnt vmcnt(7)
    s_cbranch_vccnz L_a52
    s_waitcnt vmcnt(5)
L_a52:
    s_addk_i32 m0, 1024
    s_mov_b32 s11, 0
    buffer_load_dwordx4 v21, s[68:71], s11 offen nt lds
    s_waitcnt vmcnt(7)
    s_cbranch_vccnz L_a53
    s_waitcnt vmcnt(5)
L_a53:
    s_addk_i32 m0, 1024
    s_addk_i32 s11, 9216
    buffer_load_dwordx4 v19, s[68:71], s11 offen nt lds
    s_waitcnt vmcnt(7)
    s_cbranch_vccnz L_a54
    s_waitcnt vmcnt(5)
L_a54:
    s_addk_i32 m0, 1024
    s_mov_b32 s11, 9216
    buffer_load_dwordx4 v20, s[68:71], s11 offen nt lds
    s_waitcnt vmcnt(5)
    s_mov_b64 exec, 1
    ds_add_u32 v2, v3 offset:40
    s_mov_b64 exec, -1
    s_addk_i32 m0, 1024
    s_mov_b32 s11, 9216
    buffer_load_dwordx4 v21, s[68:71], s11 offen nt lds
    s_waitcnt vmcnt(0)
    s_mov_b64 exec, 1
    ds_add_u32 v2, v3 offset:44
    s_mov_b64 exec, -1
    s_endpgm
L_notL:
    s_mul_i32 s59, s7, 21846
    s_lshr_b32 s59, s59, 16
    s_mul_i32 s57, s59, 3
    s_sub_u32 s57, s7, s57
    s_lshr_b32 s11, s5, 4
    s_mul_i32 s11, s11, 5
    s_add_u32 s8, s59, s11
    s_mul_i32 s11, s4, 9
    s_add_u32 s8, s8, s11
    s_lshr_b32 s58, 0x0fff7fff, s5
    s_and_b32 s58, s58, 1
    s_mov_b32 s92, s38
    s_mov_b32 s93, s39
    s_mov_b32 s94, 2359296
    s_mov_b32 s95, 0x20000
    v_mov_b32 v2, 147456
    v_mov_b32 v3, 1
    s_cmp_ge_u32 s3, 8
    s_cbranch_scc1 L_X
    s_setprio 2
    v_mov_b32 v8, 0
    v_mov_b32 v9, 0
    v_mov_b32 v10, 0
    v_mov_b32 v11, 0
    v_mov_b32 v12, 0
    v_mov_b32 v13, 0
    v_mov_b32 v14, 0
    v_mov_b32 v15, 0
    v_mov_b32 v24, 0
    v_mov_b32 v25, 0
    v_mov_b32 v26, 0
    v_mov_b32 v27, 0
    v_mov_b32 v28, 0
    v_mov_b32 v29, 0
    v_mov_b32 v30, 0
    v_mov_b32 v31, 0
    v_cmp_gt_u32 vcc, 32, v1
    v_mov_b32 v117, 0x3ae38e39
    s_waitcnt vmcnt(0)
    v_cndmask_b32 v20, 0, v20, vcc
    v_lshlrev_b32 v104, 16, v16
    v_and_b32 v105, 0xffff0000, v16
    v_lshlrev_b32 v106, 16, v17
    v_and_b32 v107, 0xffff0000, v17
    v_lshlrev_b32 v108, 16, v18
    v_and_b32 v109, 0xffff0000, v18
    v_lshlrev_b32 v110, 16, v19
    v_and_b32 v111, 0xffff0000, v19
    v_lshlrev_b32 v112, 16, v20
    v_and_b32 v113, 0xffff0000, v20
    v_add_f32 v120, v104, v105
    v_add_f32 v121, v106, v107
    v_add_f32 v122, v108, v109
    v_add_f32 v123, v110, v111
    v_add_f32 v124, v112, v113
    v_add_f32 v116, v120, v121
    v_add_f32 v122, v122, v123
    v_add_f32 v116, v116, v124
    v_add_f32 v116, v116, v122
    s_nop 1
    v_add_f32_dpp v116, v116, v116 row_shr:1 row_mask:0xf bank_mask:0xf bound_ctrl:0
    s_nop 1
    v_add_f32_dpp v116, v116, v116 row_shr:2 row_mask:0xf bank_mask:0xf bound_ctrl:0
    s_nop 1
    v_add_f32_dpp v116, v116, v116 row_shr:4 row_mask:0xf bank_mask:0xf bound_ctrl:0
    s_nop 1
    v_add_f32_dpp v116, v116, v116 row_shr:8 row_mask:0xf bank_mask:0xf bound_ctrl:0
    s_nop 1
    v_add_f32_dpp v116, v116, v116 row_bcast:15 row_mask:0xa bank_mask:0xf
    s_nop 1
    v_add_f32_dpp v116, v116, v116 row_bcast:31 row_mask:0xc bank_mask:0xf
    v_readfirstlane_b32 s9, v21
    s_nop 0
    s_mul_i32 s9, s9, 1664525
    s_add_u32 s9, s9, 1013904223
    v_readlane_b32 s10, v116, 63
    v_lshlrev_b32 v23, 2, v5
    v_add_u32 v23, 133120, v23
    v_mul_f32 v118, s10, v117
    v_sub_f32 v120, v104, v118
    v_sub_f32 v121, v105, v118
    v_sub_f32 v122, v106, v118
    v_sub_f32 v123, v107, v118
    v_sub_f32 v124, v108, v118
    v_sub_f32 v125, v109, v118
    v_sub_f32 v126, v110, v118
    v_sub_f32 v127, v111, v118
    v_sub_f32 v128, v112, v118
    v_sub_f32 v129, v113, v118
    v_cndmask_b32 v128, 0, v128, vcc
    v_cndmask_b32 v129, 0, v129, vcc
    v_mul_f32 v116, v120, v120
    v_mul_f32 v119, v121, v121
    v_fmac_f32 v116, v122, v122
    v_fmac_f32 v119, v123, v123
    v_fmac_f32 v116, v124, v124
    v_fmac_f32 v119, v125, v125
    v_fmac_f32 v116, v126, v126
    v_fmac_f32 v119, v127, v127
    v_fmac_f32 v116, v128, v128
    v_fmac_f32 v119, v129, v129
    v_add_f32 v116, v116, v119
    v_cvt_pk_bf16_f32 v118, v118, v118
    s_nop 1
    v_add_f32_dpp v116, v116, v116 row_shr:1 row_mask:0xf bank_mask:0xf bound_ctrl:0
    s_nop 1
    v_add_f32_dpp v116, v116, v116 row_shr:2 row_mask:0xf bank_mask:0xf bound_ctrl:0
    s_nop 1
    v_add_f32_dpp v116, v116, v116 row_shr:4 row_mask:0xf bank_mask:0xf bound_ctrl:0
    s_nop 1
    v_add_f32_dpp v116, v116, v116 row_shr:8 row_mask:0xf bank_mask:0xf bound_ctrl:0
    s_nop 1
    v_add_f32_dpp v116, v116, v116 row_bcast:15 row_mask:0xa bank_mask:0xf
    s_nop 1
    v_add_f32_dpp v116, v116, v116 row_bcast:31 row_mask:0xc bank_mask:0xf
    v_and_b32 v118, 0xffff0000, v118
    v_readlane_b32 s10, v116, 63
    v_sub_f32 v104, v104, v118
    v_sub_f32 v105, v105, v118
    v_sub_f32 v106, v106, v118
    v_sub_f32 v107, v107, v118
    v_sub_f32 v108, v108, v118
    v_sub_f32 v109, v109, v118
    v_sub_f32 v110, v110, v118
    v_sub_f32 v111, v111, v118
    v_sub_f32 v112, v112, v118
    v_sub_f32 v113, v113, v118
    v_mul_f32 v116, s10, v117
    v_cvt_pk_bf16_f32 v116, v116, v116
    v_and_b32 v116, 0xffff0000, v116
    v_add_f32 v116, 0x3727c5ac, v116
    v_cvt_pk_bf16_f32 v116, v116, v116
    v_and_b32 v116, 0xffff0000, v116
    v_sqrt_f32 v116, v116
    v_cvt_pk_bf16_f32 v120, v104, v105
    v_cvt_pk_bf16_f32 v121, v106, v107
    v_cvt_pk_bf16_f32 v122, v108, v109
    v_cvt_pk_bf16_f32 v123, v110, v111
    v_cvt_pk_bf16_f32 v124, v112, v113
    v_cvt_pk_bf16_f32 v116, v116, v116
    v_and_b32 v116, 0xffff0000, v116
    v_rcp_f32 v116, v116
    v_lshlrev_b32 v104, 16, v120
    v_and_b32 v105, 0xffff0000, v120
    v_lshlrev_b32 v106, 16, v121
    v_and_b32 v107, 0xffff0000, v121
    v_lshlrev_b32 v108, 16, v122
    v_and_b32 v109, 0xffff0000, v122
    v_lshlrev_b32 v110, 16, v123
    v_and_b32 v111, 0xffff0000, v123
    v_lshlrev_b32 v112, 16, v124
    v_and_b32 v113, 0xffff0000, v124
    v_mul_f32 v104, v104, v116
    v_mul_f32 v105, v105, v116
    v_mul_f32 v106, v106, v116
    v_mul_f32 v107, v107, v116
    v_mul_f32 v108, v108, v116
    v_mul_f32 v109, v109, v116
    v_mul_f32 v110, v110, v116
    v_mul_f32 v111, v111, v116
    v_mul_f32 v112, v112, v116
    v_mul_f32 v113, v113, v116
    v_cvt_pk_bf16_f32 v120, v104, v105
    v_cvt_pk_bf16_f32 v121, v106, v107
    v_cvt_pk_bf16_f32 v122, v108, v109
    v_cvt_pk_bf16_f32 v123, v110, v111
    v_cvt_pk_bf16_f32 v124, v112, v113
    v_add_u32 v22, 137216, v5
    v_and_b32 v104, 0xffff, v120
    v_lshlrev_b32 v105, 16, v120
    v_lshrrev_b32 v106, 16, v120
    v_and_b32 v107, 0xffff0000, v120
    ds_write_b128 v23, v[104:107] offset:0
    v_and_b32 v108, 0xffff, v121
    v_lshlrev_b32 v109, 16, v121
    v_lshrrev_b32 v110, 16, v121
    v_and_b32 v111, 0xffff0000, v121
    ds_write_b128 v23, v[108:111] offset:16
    v_and_b32 v112, 0xffff, v122
    v_lshlrev_b32 v113, 16, v122
    v_lshrrev_b32 v114, 16, v122
    v_and_b32 v115, 0xffff0000, v122
    ds_write_b128 v23, v[112:115] offset:32
    v_and_b32 v126, 0xffff, v123
    v_lshlrev_b32 v127, 16, v123
    v_lshrrev_b32 v128, 16, v123
    v_and_b32 v129, 0xffff0000, v123
    ds_write_b128 v23, v[126:129] offset:48
    v_and_b32 v130, 0xffff, v124
    v_lshlrev_b32 v131, 16, v124
    v_lshrrev_b32 v132, 16, v124
    v_and_b32 v133, 0xffff0000, v124
    ds_write_b128 v22, v[130:133]
    v_and_b32 v22, 8, v1
    v_cmp_ne_u32 vcc, 0, v22
    s_mov_b64 s[14:15], vcc
    s_cmp_lg_u32 s3, 0
    s_cbranch_scc1 L_Cgu
    s_lshr_b32 s12, s7, 2
    s_mul_i32 s12, s12, 1152
    s_add_u32 s12, s12, 133120
    v_mul_u32_u24 v22, 144, v6
    v_add_u32 v22, s12, v22
    s_lshl_b32 s10, s6, 13
    s_lshl_b32 s11, s7, 9
    s_add_u32 s10, s10, s11
    s_add_u32 s10, s10, 4096
    v_lshlrev_b32 v23, 3, v1
    v_add_u32 v23, s10, v23
    v_add_u32 v21, 114688, v5
    s_getreg_b32 s12, hwreg(HW_REG_XCC_ID, 0, 4)
    s_andn2_b32 s13, s9, 15
    s_or_b32 s12, s12, s13
    s_waitcnt lgkmcnt(0)
    ds_read_b128 v[104:107], v22 offset:0
    ds_read_b128 v[108:111], v22 offset:16
    ds_read_b128 v[112:115], v22 offset:32
    ds_read_b128 v[116:119], v22 offset:48
    ds_read_b128 v[120:123], v22 offset:64
    ds_read_b128 v[124:127], v22 offset:80
    ds_read_b128 v[128:131], v22 offset:96
    ds_read_b128 v[132:135], v22 offset:112
    ds_read_b128 v[136:139], v22 offset:128
L_w55:
    ds_read_b32 v4, v2 offset:0
    s_waitcnt lgkmcnt(0)
    v_cmp_le_u32 vcc, 4, v4
    s_cbranch_vccnz L_d56
    s_sub_u32 s56, s56, 1
    s_cbranch_scc1 L_end
    s_branch L_w55
L_d56:
    ds_read_b128 v[32:35], v21 offset:0
    ds_read_b128 v[36:39], v21 offset:1024
    ds_read_b128 v[40:43], v21 offset:2048
    ds_read_b128 v[44:47], v21 offset:3072
    ds_read_b128 v[48:51], v21 offset:4096
    ds_read_b128 v[52:55], v21 offset:5120
    ds_read_b128 v[56:59], v21 offset:6144
    ds_read_b128 v[60:63], v21 offset:7168
    ds_read_b128 v[64:67], v21 offset:8192
    ds_read_b128 v[68:71], v21 offset:9216
    ds_read_b128 v[72:75], v21 offset:10240
    ds_read_b128 v[76:79], v21 offset:11264
    ds_read_b128 v[80:83], v21 offset:12288
    ds_read_b128 v[84:87], v21 offset:13312
    ds_read_b128 v[88:91], v21 offset:14336
    ds_read_b128 v[92:95], v21 offset:15360
    ds_read_b128 v[96:99], v21 offset:16384
    ds_read_b128 v[100:103], v21 offset:17408
    s_waitcnt lgkmcnt(15)
    v_dot2c_f32_bf16 v8, v32, v104
    v_dot2c_f32_bf16 v9, v32, v105
    v_dot2c_f32_bf16 v10, v33, v104
    v_dot2c_f32_bf16 v11, v33, v105
    v_dot2c_f32_bf16 v12, v34, v104
    v_dot2c_f32_bf16 v13, v34, v105
    v_dot2c_f32_bf16 v14, v35, v104
    v_dot2c_f32_bf16 v15, v35, v105
    v_dot2c_f32_bf16 v8, v36, v106
    v_dot2c_f32_bf16 v9, v36, v107
    v_dot2c_f32_bf16 v10, v37, v106
    v_dot2c_f32_bf16 v11, v37, v107
    v_dot2c_f32_bf16 v12, v38, v106
    v_dot2c_f32_bf16 v13, v38, v107
    v_dot2c_f32_bf16 v14, v39, v106
    v_dot2c_f32_bf16 v15, v39, v107
    v_dot2c_f32_bf16 v8, v40, v108
    v_dot2c_f32_bf16 v9, v40, v109
    v_dot2c_f32_bf16 v10, v41, v108
    v_dot2c_f32_bf16 v11, v41, v109
    v_dot2c_f32_bf16 v12, v42, v108
    v_dot2c_f32_bf16 v13, v42, v109
    v_dot2c_f32_bf16 v14, v43, v108
    v_dot2c_f32_bf16 v15, v43, v109
    s_waitcnt lgkmcnt(12)
    v_dot2c_f32_bf16 v8, v44, v110
    v_dot2c_f32_bf16 v9, v44, v111
    v_dot2c_f32_bf16 v10, v45, v110
    v_dot2c_f32_bf16 v11, v45, v111
    v_dot2c_f32_bf16 v12, v46, v110
    v_dot2c_f32_bf16 v13, v46, v111
    v_dot2c_f32_bf16 v14, v47, v110
    v_dot2c_f32_bf16 v15, v47, v111
    v_dot2c_f32_bf16 v8, v48, v112
    v_dot2c_f32_bf16 v9, v48, v113
    v_dot2c_f32_bf16 v10, v49, v112
    v_dot2c_f32_bf16 v11, v49, v113
    v_dot2c_f32_bf16 v12, v50, v112
    v_dot2c_f32_bf16 v13, v50, v113
    v_dot2c_f32_bf16 v14, v51, v112
    v_dot2c_f32_bf16 v15, v51, v113
    v_dot2c_f32_bf16 v8, v52, v114
    v_dot2c_f32_bf16 v9, v52, v115
    v_dot2c_f32_bf16 v10, v53, v114
    v_dot2c_f32_bf16 v11, v53, v115
    v_dot2c_f32_bf16 v12, v54, v114
    v_dot2c_f32_bf16 v13, v54, v115
    v_dot2c_f32_bf16 v14, v55, v114
    v_dot2c_f32_bf16 v15, v55, v115
    s_waitcnt lgkmcnt(9)
    v_dot2c_f32_bf16 v8, v56, v116
    v_dot2c_f32_bf16 v9, v56, v117
    v_dot2c_f32_bf16 v10, v57, v116
    v_dot2c_f32_bf16 v11, v57, v117
    v_dot2c_f32_bf16 v12, v58, v116
    v_dot2c_f32_bf16 v13, v58, v117
    v_dot2c_f32_bf16 v14, v59, v116
    v_dot2c_f32_bf16 v15, v59, v117
    v_dot2c_f32_bf16 v8, v60, v118
    v_dot2c_f32_bf16 v9, v60, v119
    v_dot2c_f32_bf16 v10, v61, v118
    v_dot2c_f32_bf16 v11, v61, v119
    v_dot2c_f32_bf16 v12, v62, v118
    v_dot2c_f32_bf16 v13, v62, v119
    v_dot2c_f32_bf16 v14, v63, v118
    v_dot2c_f32_bf16 v15, v63, v119
    v_dot2c_f32_bf16 v8, v64, v120
    v_dot2c_f32_bf16 v9, v64, v121
    v_dot2c_f32_bf16 v10, v65, v120
    v_dot2c_f32_bf16 v11, v65, v121
    v_dot2c_f32_bf16 v12, v66, v120
    v_dot2c_f32_bf16 v13, v66, v121
    v_dot2c_f32_bf16 v14, v67, v120
    v_dot2c_f32_bf16 v15, v67, v121
    s_waitcnt lgkmcnt(6)
    v_dot2c_f32_bf16 v8, v68, v122
    v_dot2c_f32_bf16 v9, v68, v123
    v_dot2c_f32_bf16 v10, v69, v122
    v_dot2c_f32_bf16 v11, v69, v123
    v_dot2c_f32_bf16 v12, v70, v122
    v_dot2c_f32_bf16 v13, v70, v123
    v_dot2c_f32_bf16 v14, v71, v122
    v_dot2c_f32_bf16 v15, v71, v123
    v_dot2c_f32_bf16 v8, v72, v124
    v_dot2c_f32_bf16 v9, v72, v125
    v_dot2c_f32_bf16 v10, v73, v124
    v_dot2c_f32_bf16 v11, v73, v125
    v_dot2c_f32_bf16 v12, v74, v124
    v_dot2c_f32_bf16 v13, v74, v125
    v_dot2c_f32_bf16 v14, v75, v124
    v_dot2c_f32_bf16 v15, v75, v125
    v_dot2c_f32_bf16 v8, v76, v126
    v_dot2c_f32_bf16 v9, v76, v127
    v_dot2c_f32_bf16 v10, v77, v126
    v_dot2c_f32_bf16 v11, v77, v127
    v_dot2c_f32_bf16 v12, v78, v126
    v_dot2c_f32_bf16 v13, v78, v127
    v_dot2c_f32_bf16 v14, v79, v126
    v_dot2c_f32_bf16 v15, v79, v127
    s_waitcnt lgkmcnt(3)
    v_dot2c_f32_bf16 v8, v80, v128
    v_dot2c_f32_bf16 v9, v80, v129
    v_dot2c_f32_bf16 v10, v81, v128
    v_dot2c_f32_bf16 v11, v81, v129
    v_dot2c_f32_bf16 v12, v82, v128
    v_dot2c_f32_bf16 v13, v82, v129
    v_dot2c_f32_bf16 v14, v83, v128
    v_dot2c_f32_bf16 v15, v83, v129
    v_dot2c_f32_bf16 v8, v84, v130
    v_dot2c_f32_bf16 v9, v84, v131
    v_dot2c_f32_bf16 v10, v85, v130
    v_dot2c_f32_bf16 v11, v85, v131
    v_dot2c_f32_bf16 v12, v86, v130
    v_dot2c_f32_bf16 v13, v86, v131
    v_dot2c_f32_bf16 v14, v87, v130
    v_dot2c_f32_bf16 v15, v87, v131
    v_dot2c_f32_bf16 v8, v88, v132
    v_dot2c_f32_bf16 v9, v88, v133
    v_dot2c_f32_bf16 v10, v89, v132
    v_dot2c_f32_bf16 v11, v89, v133
    v_dot2c_f32_bf16 v12, v90, v132
    v_dot2c_f32_bf16 v13, v90, v133
    v_dot2c_f32_bf16 v14, v91, v132
    v_dot2c_f32_bf16 v15, v91, v133
    s_waitcnt lgkmcnt(0)
    v_dot2c_f32_bf16 v8, v92, v134
    v_dot2c_f32_bf16 v9, v92, v135
    v_dot2c_f32_bf16 v10, v93, v134
    v_dot2c_f32_bf16 v11, v93, v135
    v_dot2c_f32_bf16 v12, v94, v134
    v_dot2c_f32_bf16 v13, v94, v135
    v_dot2c_f32_bf16 v14, v95, v134
    v_dot2c_f32_bf16 v15, v95, v135
    v_dot2c_f32_bf16 v8, v96, v136
    v_dot2c_f32_bf16 v9, v96, v137
    v_dot2c_f32_bf16 v10, v97, v136
    v_dot2c_f32_bf16 v11, v97, v137
    v_dot2c_f32_bf16 v12, v98, v136
    v_dot2c_f32_bf16 v13, v98, v137
    v_dot2c_f32_bf16 v14, v99, v136
    v_dot2c_f32_bf16 v15, v99, v137
    v_dot2c_f32_bf16 v8, v100, v138
    v_dot2c_f32_bf16 v9, v100, v139
    v_dot2c_f32_bf16 v10, v101, v138
    v_dot2c_f32_bf16 v11, v101, v139
    v_dot2c_f32_bf16 v12, v102, v138
    v_dot2c_f32_bf16 v13, v102, v139
    v_dot2c_f32_bf16 v14, v103, v138
    v_dot2c_f32_bf16 v15, v103, v139
    s_mov_b64 vcc, s[14:15]
    s_nop 1
    v_permlane32_swap_b32 v8, v9
    v_permlane32_swap_b32 v10, v11
    v_permlane32_swap_b32 v12, v13
    v_permlane32_swap_b32 v14, v15
    v_add_f32 v8, v8, v9
    v_add_f32 v10, v10, v11
    v_add_f32 v12, v12, v13
    v_add_f32 v14, v14, v15
    s_nop 0
    v_permlane16_swap_b32 v8, v10
    v_permlane16_swap_b32 v12, v14
    v_add_f32 v8, v8, v10
    v_add_f32 v12, v12, v14
    s_nop 0
    v_add_f32_dpp v8, v8, v8 row_ror:8 row_mask:0xf bank_mask:0xf
    v_add_f32_dpp v12, v12, v12 row_ror:8 row_mask:0xf bank_mask:0xf
    v_cndmask_b32 v8, v8, v12, vcc
    v_mov_b32 v9, s12
    buffer_store_dwordx2 v[8:9], v23, s[92:95], 0 offen
    v_lshlrev_b32 v22, 3, v1
    v_add_u32 v22, 138752, v22
    ds_write_b64 v22, v[8:9]
    s_mov_b64 exec, 1
    ds_add_u32 v2, v3 offset:56
    s_mov_b64 exec, -1
    s_branch L_Cscores
L_Cgu:
    s_cmp_eq_u32 s58, 0
    s_cbranch_scc1 L_Cgu_none
    s_sub_u32 s13, s3, 1
    s_mul_i32 s12, s57, 1536
    s_lshl_b32 s11, s13, 9
    s_add_u32 s12, s12, s11
    s_add_u32 s12, s12, 133120
    v_lshlrev_b32 v22, 6, v6
    v_add_u32 v22, s12, v22
    s_lshl_b32 s10, s8, 14
    s_lshl_b32 s11, s57, 10
    s_add_u32 s10, s10, s11
    s_add_u32 s10, s10, 1179648
    v_add_u32 v23, s10, v5
    s_lshl_b32 s11, s13, 14
    s_add_u32 s11, s11, 65536
    v_add_u32 v21, s11, v5
    s_waitcnt lgkmcnt(0)
    ds_read_b128 v[104:107], v22 offset:0
    ds_read_b128 v[108:111], v22 offset:16
    ds_read_b128 v[112:115], v22 offset:32
    ds_read_b128 v[116:119], v22 offset:48
L_w57:
    ds_read_b32 v4, v2 offset:4
    s_waitcnt lgkmcnt(0)
    v_cmp_le_u32 vcc, 4, v4
    s_cbranch_vccnz L_d58
    s_sub_u32 s56, s56, 1
    s_cbranch_scc1 L_end
    s_sleep 1
    s_branch L_w57
L_d58:
    ds_read_b128 v[32:35], v21 offset:0
    ds_read_b128 v[36:39], v21 offset:1024
    ds_read_b128 v[40:43], v21 offset:2048
    ds_read_b128 v[44:47], v21 offset:3072
    ds_read_b128 v[48:51], v21 offset:4096
    ds_read_b128 v[52:55], v21 offset:5120
    ds_read_b128 v[56:59], v21 offset:6144
    ds_read_b128 v[60:63], v21 offset:7168
    ds_read_b128 v[64:67], v21 offset:8192
    ds_read_b128 v[68:71], v21 offset:9216
    ds_read_b128 v[72:75], v21 offset:10240
    ds_read_b128 v[76:79], v21 offset:11264
    ds_read_b128 v[80:83], v21 offset:12288
    ds_read_b128 v[84:87], v21 offset:13312
    ds_read_b128 v[88:91], v21 offset:14336
    ds_read_b128 v[92:95], v21 offset:15360
    s_waitcnt lgkmcnt(12)
    v_dot2c_f32_bf16 v8, v32, v104
    v_dot2c_f32_bf16 v9, v32, v105
    v_dot2c_f32_bf16 v10, v33, v104
    v_dot2c_f32_bf16 v11, v33, v105
    v_dot2c_f32_bf16 v12, v34, v104
    v_dot2c_f32_bf16 v13, v34, v105
    v_dot2c_f32_bf16 v14, v35, v104
    v_dot2c_f32_bf16 v15, v35, v105
    v_dot2c_f32_bf16 v8, v36, v106
    v_dot2c_f32_bf16 v9, v36, v107
    v_dot2c_f32_bf16 v10, v37, v106
    v_dot2c_f32_bf16 v11, v37, v107
    v_dot2c_f32_bf16 v12, v38, v106
    v_dot2c_f32_bf16 v13, v38, v107
    v_dot2c_f32_bf16 v14, v39, v106
    v_dot2c_f32_bf16 v15, v39, v107
    v_dot2c_f32_bf16 v8, v40, v108
    v_dot2c_f32_bf16 v9, v40, v109
    v_dot2c_f32_bf16 v10, v41, v108
    v_dot2c_f32_bf16 v11, v41, v109
    v_dot2c_f32_bf16 v12, v42, v108
    v_dot2c_f32_bf16 v13, v42, v109
    v_dot2c_f32_bf16 v14, v43, v108
    v_dot2c_f32_bf16 v15, v43, v109
    v_dot2c_f32_bf16 v8, v44, v110
    v_dot2c_f32_bf16 v9, v44, v111
    v_dot2c_f32_bf16 v10, v45, v110
    v_dot2c_f32_bf16 v11, v45, v111
    v_dot2c_f32_bf16 v12, v46, v110
    v_dot2c_f32_bf16 v13, v46, v111
    v_dot2c_f32_bf16 v14, v47, v110
    v_dot2c_f32_bf16 v15, v47, v111
    s_waitcnt lgkmcnt(8)
    v_dot2c_f32_bf16 v8, v48, v112
    v_dot2c_f32_bf16 v9, v48, v113
    v_dot2c_f32_bf16 v10, v49, v112
    v_dot2c_f32_bf16 v11, v49, v113
    v_dot2c_f32_bf16 v12, v50, v112
    v_dot2c_f32_bf16 v13, v50, v113
    v_dot2c_f32_bf16 v14, v51, v112
    v_dot2c_f32_bf16 v15, v51, v113
    v_dot2c_f32_bf16 v8, v52, v114
    v_dot2c_f32_bf16 v9, v52, v115
    v_dot2c_f32_bf16 v10, v53, v114
    v_dot2c_f32_bf16 v11, v53, v115
    v_dot2c_f32_bf16 v12, v54, v114
    v_dot2c_f32_bf16 v13, v54, v115
    v_dot2c_f32_bf16 v14, v55, v114
    v_dot2c_f32_bf16 v15, v55, v115
    v_dot2c_f32_bf16 v8, v56, v116
    v_dot2c_f32_bf16 v9, v56, v117
    v_dot2c_f32_bf16 v10, v57, v116
    v_dot2c_f32_bf16 v11, v57, v117
    v_dot2c_f32_bf16 v12, v58, v116
    v_dot2c_f32_bf16 v13, v58, v117
    v_dot2c_f32_bf16 v14, v59, v116
    v_dot2c_f32_bf16 v15, v59, v117
    v_dot2c_f32_bf16 v8, v60, v118
    v_dot2c_f32_bf16 v9, v60, v119
    v_dot2c_f32_bf16 v10, v61, v118
    v_dot2c_f32_bf16 v11, v61, v119
    v_dot2c_f32_bf16 v12, v62, v118
    v_dot2c_f32_bf16 v13, v62, v119
    v_dot2c_f32_bf16 v14, v63, v118
    v_dot2c_f32_bf16 v15, v63, v119
    s_waitcnt lgkmcnt(4)
    v_dot2c_f32_bf16 v24, v64, v104
    v_dot2c_f32_bf16 v25, v64, v105
    v_dot2c_f32_bf16 v26, v65, v104
    v_dot2c_f32_bf16 v27, v65, v105
    v_dot2c_f32_bf16 v28, v66, v104
    v_dot2c_f32_bf16 v29, v66, v105
    v_dot2c_f32_bf16 v30, v67, v104
    v_dot2c_f32_bf16 v31, v67, v105
    v_dot2c_f32_bf16 v24, v68, v106
    v_dot2c_f32_bf16 v25, v68, v107
    v_dot2c_f32_bf16 v26, v69, v106
    v_dot2c_f32_bf16 v27, v69, v107
    v_dot2c_f32_bf16 v28, v70, v106
    v_dot2c_f32_bf16 v29, v70, v107
    v_dot2c_f32_bf16 v30, v71, v106
    v_dot2c_f32_bf16 v31, v71, v107
    v_dot2c_f32_bf16 v24, v72, v108
    v_dot2c_f32_bf16 v25, v72, v109
    v_dot2c_f32_bf16 v26, v73, v108
    v_dot2c_f32_bf16 v27, v73, v109
    v_dot2c_f32_bf16 v28, v74, v108
    v_dot2c_f32_bf16 v29, v74, v109
    v_dot2c_f32_bf16 v30, v75, v108
    v_dot2c_f32_bf16 v31, v75, v109
    v_dot2c_f32_bf16 v24, v76, v110
    v_dot2c_f32_bf16 v25, v76, v111
    v_dot2c_f32_bf16 v26, v77, v110
    v_dot2c_f32_bf16 v27, v77, v111
    v_dot2c_f32_bf16 v28, v78, v110
    v_dot2c_f32_bf16 v29, v78, v111
    v_dot2c_f32_bf16 v30, v79, v110
    v_dot2c_f32_bf16 v31, v79, v111
    s_waitcnt lgkmcnt(0)
    s_mov_b64 exec, 1
    ds_add_u32 v2, v3 offset:80
    s_mov_b64 exec, -1
    v_dot2c_f32_bf16 v24, v80, v112
    v_dot2c_f32_bf16 v25, v80, v113
    v_dot2c_f32_bf16 v26, v81, v112
    v_dot2c_f32_bf16 v27, v81, v113
    v_dot2c_f32_bf16 v28, v82, v112
    v_dot2c_f32_bf16 v29, v82, v113
    v_dot2c_f32_bf16 v30, v83, v112
    v_dot2c_f32_bf16 v31, v83, v113
    v_dot2c_f32_bf16 v24, v84, v114
    v_dot2c_f32_bf16 v25, v84, v115
    v_dot2c_f32_bf16 v26, v85, v114
    v_dot2c_f32_bf16 v27, v85, v115
    v_dot2c_f32_bf16 v28, v86, v114
    v_dot2c_f32_bf16 v29, v86, v115
    v_dot2c_f32_bf16 v30, v87, v114
    v_dot2c_f32_bf16 v31, v87, v115
    v_dot2c_f32_bf16 v24, v88, v116
    v_dot2c_f32_bf16 v25, v88, v117
    v_dot2c_f32_bf16 v26, v89, v116
    v_dot2c_f32_bf16 v27, v89, v117
    v_dot2c_f32_bf16 v28, v90, v116
    v_dot2c_f32_bf16 v29, v90, v117
    v_dot2c_f32_bf16 v30, v91, v116
    v_dot2c_f32_bf16 v31, v91, v117
    v_dot2c_f32_bf16 v24, v92, v118
    v_dot2c_f32_bf16 v25, v92, v119
    v_dot2c_f32_bf16 v26, v93, v118
    v_dot2c_f32_bf16 v27, v93, v119
    v_dot2c_f32_bf16 v28, v94, v118
    v_dot2c_f32_bf16 v29, v94, v119
    v_dot2c_f32_bf16 v30, v95, v118
    v_dot2c_f32_bf16 v31, v95, v119
    s_mov_b64 vcc, s[14:15]
    s_nop 1
    v_permlane32_swap_b32 v8, v9
    v_permlane32_swap_b32 v10, v11
    v_permlane32_swap_b32 v12, v13
    v_permlane32_swap_b32 v14, v15
    v_permlane32_swap_b32 v24, v25
    v_permlane32_swap_b32 v26, v27
    v_permlane32_swap_b32 v28, v29
    v_permlane32_swap_b32 v30, v31
    v_add_f32 v8, v8, v9
    v_add_f32 v10, v10, v11
    v_add_f32 v12, v12, v13
    v_add_f32 v14, v14, v15
    v_add_f32 v24, v24, v25
    v_add_f32 v26, v26, v27
    v_add_f32 v28, v28, v29
    v_add_f32 v30, v30, v31
    s_nop 0
    v_permlane16_swap_b32 v8, v10
    v_permlane16_swap_b32 v12, v14
    v_permlane16_swap_b32 v24, v26
    v_permlane16_swap_b32 v28, v30
    v_add_f32 v8, v8, v10
    v_add_f32 v12, v12, v14
    v_add_f32 v24, v24, v26
    v_add_f32 v28, v28, v30
    s_nop 0
    v_add_f32_dpp v8, v8, v8 row_ror:8 row_mask:0xf bank_mask:0xf
    v_add_f32_dpp v12, v12, v12 row_ror:8 row_mask:0xf bank_mask:0xf
    v_add_f32_dpp v24, v24, v24 row_ror:8 row_mask:0xf bank_mask:0xf
    v_add_f32_dpp v28, v28, v28 row_ror:8 row_mask:0xf bank_mask:0xf
    v_cndmask_b32 v8, v8, v12, vcc
    v_cndmask_b32 v24, v24, v28, vcc
    v_lshlrev_b32 v22, 2, v1
    v_add_u32 v22, 148480, v22
    ds_add_f32 v22, v8
    ds_add_f32 v22, v24 offset:256
    s_mov_b64 exec, 1
    ds_add_rtn_u32 v4, v2, v3 offset:92
    s_mov_b64 exec, -1
    ds_read_b32 v8, v22
    ds_read_b32 v9, v22 offset:256
    v_mov_b32 v10, s9
    v_mov_b32 v11, s9
    s_waitcnt lgkmcnt(0)
    v_readfirstlane_b32 s11, v4
    s_nop 0
    s_cmp_lg_u32 s11, 2
    s_cbranch_scc1 L_Cscores
L_w59:
    ds_read_b32 v4, v2 offset:76
    s_waitcnt lgkmcnt(0)
    v_cmp_le_u32 vcc, 1, v4
    s_cbranch_vccnz L_d60
    s_sub_u32 s56, s56, 1
    s_cbranch_scc1 L_end
    s_sleep 1
    s_branch L_w59
L_d60:
    v_readfirstlane_b32 s55, v4
    s_cmp_eq_u32 s55, 1
    s_cbranch_scc1 L_m61
    buffer_store_dwordx4 v[8:11], v23, s[92:95], 0 offen sc1
    s_branch L_m62
L_m61:
    buffer_store_dwordx4 v[8:11], v23, s[92:95], 0 offen
L_m62:
    s_mov_b64 exec, 1
    ds_add_u32 v2, v3 offset:60
    s_mov_b64 exec, -1
    s_branch L_Cscores
L_Cgu_none:
    s_mov_b64 exec, 1
    ds_add_u32 v2, v3 offset:80
    s_mov_b64 exec, -1
L_Cscores:
    v_and_b32 v22, 15, v1
    v_lshrrev_b32 v23, 4, v1
    s_lshl_b32 s10, s3, 14
    v_xor_b32 v24, v23, v22
    v_lshlrev_b32 v24, 4, v24
    v_lshl_add_u32 v24, v22, 8, v24
    v_add_u32 v24, s10, v24
    v_xor_b32 v25, 64, v24
    v_xor_b32 v26, 128, v24
    v_xor_b32 v27, 192, v24
    v_and_b32 v28, 1, v1
    v_lshlrev_b32 v29, 8, v28
    v_lshl_add_u32 v29, v23, 4, v29
    v_add_u32 v29, 138240, v29
    v_lshlrev_b32 v30, 4, v28
    v_add_u32 v30, 147552, v30
    s_lshl_b32 s10, s3, 2
    v_add_u32 v31, s10, v30
    s_lshl_b32 s10, s3, 11
    s_add_u32 s10, s10, 139264
    v_add_u32 v18, s10, v5
    v_add_u32 v19, 139264, v5
    s_mov_b32 s10, 0x3db504f3
    s_mov_b32 s11, 0x3fb8aa3b
L_w63:
    ds_read_b32 v4, v2 offset:8
    s_waitcnt lgkmcnt(0)
    v_cmp_le_u32 vcc, 5, v4
    s_cbranch_vccnz L_d64
    s_sub_u32 s56, s56, 1
    s_cbranch_scc1 L_end
    s_sleep 1
    s_branch L_w63
L_d64:
    ds_read_b128 v[96:99], v29 offset:0
    ds_read_b128 v[100:103], v29 offset:64
    ds_read_b128 v[104:107], v29 offset:128
    ds_read_b128 v[108:111], v29 offset:192
    ds_read_b128 v[32:35], v24 offset:0
    ds_read_b128 v[48:51], v24 offset:4096
    ds_read_b128 v[64:67], v24 offset:8192
    ds_read_b128 v[80:83], v24 offset:12288
    ds_read_b128 v[36:39], v25 offset:0
    ds_read_b128 v[52:55], v25 offset:4096
    ds_read_b128 v[68:71], v25 offset:8192
    ds_read_b128 v[84:87], v25 offset:12288
    ds_read_b128 v[40:43], v26 offset:0
    ds_read_b128 v[56:59], v26 offset:4096
    ds_read_b128 v[72:75], v26 offset:8192
    ds_read_b128 v[88:91], v26 offset:12288
    ds_read_b128 v[44:47], v27 offset:0
    ds_read_b128 v[60:63], v27 offset:4096
    ds_read_b128 v[76:79], v27 offset:8192
    ds_read_b128 v[92:95], v27 offset:12288
    s_waitcnt lgkmcnt(12)
    v_mfma_f32_16x16x32_bf16 v[112:115], v[32:35], v[96:99], 0
    v_mfma_f32_16x16x32_bf16 v[116:119], v[48:51], v[96:99], 0
    v_mfma_f32_16x16x32_bf16 v[120:123], v[64:67], v[96:99], 0
    v_mfma_f32_16x16x32_bf16 v[124:127], v[80:83], v[96:99], 0
    s_waitcnt lgkmcnt(8)
    v_mfma_f32_16x16x32_bf16 v[112:115], v[36:39], v[100:103], v[112:115]
    v_mfma_f32_16x16x32_bf16 v[116:119], v[52:55], v[100:103], v[116:119]
    v_mfma_f32_16x16x32_bf16 v[120:123], v[68:71], v[100:103], v[120:123]
    v_mfma_f32_16x16x32_bf16 v[124:127], v[84:87], v[100:103], v[124:127]
    s_waitcnt lgkmcnt(4)
    v_mfma_f32_16x16x32_bf16 v[112:115], v[40:43], v[104:107], v[112:115]
    v_mfma_f32_16x16x32_bf16 v[116:119], v[56:59], v[104:107], v[116:119]
    v_mfma_f32_16x16x32_bf16 v[120:123], v[72:75], v[104:107], v[120:123]
    v_mfma_f32_16x16x32_bf16 v[124:127], v[88:91], v[104:107], v[124:127]
    s_waitcnt lgkmcnt(0)
    s_mov_b64 exec, 1
    ds_add_u32 v2, v3 offset:12
    s_mov_b64 exec, -1
    v_mfma_f32_16x16x32_bf16 v[112:115], v[44:47], v[108:111], v[112:115]
    v_mfma_f32_16x16x32_bf16 v[116:119], v[60:63], v[108:111], v[116:119]
    v_mfma_f32_16x16x32_bf16 v[120:123], v[76:79], v[108:111], v[120:123]
    v_mfma_f32_16x16x32_bf16 v[124:127], v[92:95], v[108:111], v[124:127]
    s_nop 4
    v_cvt_pk_bf16_f32 v32, v112, v113
    v_cvt_pk_bf16_f32 v33, v114, v115
    v_cvt_pk_bf16_f32 v34, v116, v117
    v_cvt_pk_bf16_f32 v35, v118, v119
    v_cvt_pk_bf16_f32 v36, v120, v121
    v_cvt_pk_bf16_f32 v37, v122, v123
    v_cvt_pk_bf16_f32 v38, v124, v125
    v_cvt_pk_bf16_f32 v39, v126, v127
    v_lshlrev_b32 v112, 16, v32
    v_and_b32 v113, 0xffff0000, v32
    v_lshlrev_b32 v114, 16, v33
    v_and_b32 v115, 0xffff0000, v33
    v_lshlrev_b32 v116, 16, v34
    v_and_b32 v117, 0xffff0000, v34
    v_lshlrev_b32 v118, 16, v35
    v_and_b32 v119, 0xffff0000, v35
    v_lshlrev_b32 v120, 16, v36
    v_and_b32 v121, 0xffff0000, v36
    v_lshlrev_b32 v122, 16, v37
    v_and_b32 v123, 0xffff0000, v37
    v_lshlrev_b32 v124, 16, v38
    v_and_b32 v125, 0xffff0000, v38
    v_lshlrev_b32 v126, 16, v39
    v_and_b32 v127, 0xffff0000, v39
    v_mul_f32 v112, s10, v112
    v_mul_f32 v113, s10, v113
    v_mul_f32 v114, s10, v114
    v_mul_f32 v115, s10, v115
    v_mul_f32 v116, s10, v116
    v_mul_f32 v117, s10, v117
    v_mul_f32 v118, s10, v118
    v_mul_f32 v119, s10, v119
    v_mul_f32 v120, s10, v120
    v_mul_f32 v121, s10, v121
    v_mul_f32 v122, s10, v122
    v_mul_f32 v123, s10, v123
    v_mul_f32 v124, s10, v124
    v_mul_f32 v125, s10, v125
    v_mul_f32 v126, s10, v126
    v_mul_f32 v127, s10, v127
    v_cvt_pk_bf16_f32 v32, v112, v113
    v_cvt_pk_bf16_f32 v33, v114, v115
    v_cvt_pk_bf16_f32 v34, v116, v117
    v_cvt_pk_bf16_f32 v35, v118, v119
    v_cvt_pk_bf16_f32 v36, v120, v121
    v_cvt_pk_bf16_f32 v37, v122, v123
    v_cvt_pk_bf16_f32 v38, v124, v125
    v_cvt_pk_bf16_f32 v39, v126, v127
    v_lshlrev_b32 v112, 16, v32
    v_and_b32 v113, 0xffff0000, v32
    v_lshlrev_b32 v114, 16, v33
    v_and_b32 v115, 0xffff0000, v33
    v_lshlrev_b32 v116, 16, v34
    v_and_b32 v117, 0xffff0000, v34
    v_lshlrev_b32 v118, 16, v35
    v_and_b32 v119, 0xffff0000, v35
    v_lshlrev_b32 v120, 16, v36
    v_and_b32 v121, 0xffff0000, v36
    v_lshlrev_b32 v122, 16, v37
    v_and_b32 v123, 0xffff0000, v37
    v_lshlrev_b32 v124, 16, v38
    v_and_b32 v125, 0xffff0000, v38
    v_lshlrev_b32 v126, 16, v39
    v_and_b32 v127, 0xffff0000, v39
    v_max3_f32 v40, v112, v113, v114
    v_max3_f32 v41, v115, v116, v117
    v_max3_f32 v40, v40, v118, v119
    v_max3_f32 v41, v41, v120, v121
    v_max3_f32 v40, v40, v122, v123
    v_max3_f32 v41, v41, v124, v125
    v_max3_f32 v40, v40, v126, v127
    v_max_f32 v40, v40, v41
    v_mov_b32 v41, v40
    s_nop 1
    v_permlane32_swap_b32 v40, v41
    v_max_f32 v40, v40, v41
    v_mov_b32 v41, v40
    s_nop 1
    v_permlane16_swap_b32 v40, v41
    v_max_f32 v40, v40, v41
    ds_write_b32 v31, v40
    s_mov_b64 exec, 1
    ds_add_u32 v2, v3 offset:16
    s_mov_b64 exec, -1
L_w65:
    ds_read_b32 v4, v2 offset:16
    ds_read_b128 v[40:43], v30
    s_waitcnt lgkmcnt(0)
    v_cmp_le_u32 vcc, 4, v4
    s_cbranch_vccnz L_d66
    s_sub_u32 s56, s56, 1
    s_cbranch_scc1 L_end
    s_branch L_w65
L_d66:
    v_max3_f32 v40, v40, v41, v42
    v_max_f32 v40, v40, v43
    v_mul_f32 v40, s11, v40
    v_fma_f32 v112, v112, s11, -v40
    v_fma_f32 v113, v113, s11, -v40
    v_fma_f32 v114, v114, s11, -v40
    v_fma_f32 v115, v115, s11, -v40
    v_fma_f32 v116, v116, s11, -v40
    v_fma_f32 v117, v117, s11, -v40
    v_fma_f32 v118, v118, s11, -v40
    v_fma_f32 v119, v119, s11, -v40
    v_fma_f32 v120, v120, s11, -v40
    v_fma_f32 v121, v121, s11, -v40
    v_fma_f32 v122, v122, s11, -v40
    v_fma_f32 v123, v123, s11, -v40
    v_fma_f32 v124, v124, s11, -v40
    v_fma_f32 v125, v125, s11, -v40
    v_fma_f32 v126, v126, s11, -v40
    v_fma_f32 v127, v127, s11, -v40
    v_exp_f32 v112, v112
    v_exp_f32 v113, v113
    v_exp_f32 v114, v114
    v_exp_f32 v115, v115
    v_exp_f32 v116, v116
    v_exp_f32 v117, v117
    v_exp_f32 v118, v118
    v_exp_f32 v119, v119
    v_exp_f32 v120, v120
    v_exp_f32 v121, v121
    v_exp_f32 v122, v122
    v_exp_f32 v123, v123
    v_exp_f32 v124, v124
    v_exp_f32 v125, v125
    v_exp_f32 v126, v126
    v_exp_f32 v127, v127
    s_nop 0
    v_cvt_pk_bf16_f32 v32, v112, v113
    v_cvt_pk_bf16_f32 v33, v114, v115
    v_cvt_pk_bf16_f32 v34, v116, v117
    v_cvt_pk_bf16_f32 v35, v118, v119
    v_cvt_pk_bf16_f32 v36, v120, v121
    v_cvt_pk_bf16_f32 v37, v122, v123
    v_cvt_pk_bf16_f32 v38, v124, v125
    v_cvt_pk_bf16_f32 v39, v126, v127
    ds_write_b128 v18, v[32:35]
    ds_write_b128 v18, v[36:39] offset:1024
    v_add_f32 v112, v112, v116
    v_add_f32 v113, v113, v117
    v_add_f32 v114, v114, v118
    v_add_f32 v115, v115, v119
    v_add_f32 v120, v120, v124
    v_add_f32 v121, v121, v125
    v_add_f32 v122, v122, v126
    v_add_f32 v123, v123, v127
    v_add_f32 v112, v112, v120
    v_add_f32 v113, v113, v121
    v_add_f32 v114, v114, v122
    v_add_f32 v115, v115, v123
    v_add_f32 v112, v112, v113
    v_add_f32 v114, v114, v115
    v_add_f32 v112, v112, v114
    v_mov_b32 v113, v112
    s_nop 1
    v_permlane32_swap_b32 v112, v113
    v_add_f32 v112, v112, v113
    v_mov_b32 v113, v112
    s_nop 1
    v_permlane16_swap_b32 v112, v113
    v_add_f32 v112, v112, v113
    ds_write_b32 v31, v112 offset:32
    s_mov_b64 exec, 1
    ds_add_u32 v2, v3 offset:20
    s_mov_b64 exec, -1
    v_lshrrev_b32 v24, 2, v22
    v_lshl_add_u32 v24, v23, 2, v24
    v_and_b32 v25, 7, v24
    s_lshl_b32 s10, s3, 1
    v_xor_b32 v25, s10, v25
    v_and_b32 v20, 3, v22
    v_lshlrev_b32 v20, 3, v20
    v_lshlrev_b32 v25, 5, v25
    v_lshl_add_u32 v25, v24, 8, v25
    v_add_u32 v25, v20, v25
    v_add_u32 v25, 65536, v25
    v_xor_b32 v26, 32, v25
    v_and_b32 v27, 1, v23
    v_lshlrev_b32 v27, 14, v27
    v_lshrrev_b32 v28, 1, v23
    v_lshl_add_u32 v27, v28, 11, v27
    v_lshl_add_u32 v27, v22, 3, v27
    s_lshl_b32 s10, s6, 15
    s_lshl_b32 s11, s3, 12
    s_add_u32 s10, s10, s11
    s_lshl_b32 s11, s7, 7
    s_add_u32 s10, s10, s11
    s_add_u32 s10, s10, 655360
    v_add_u32 v27, s10, v27
    v_and_b32 v28, 1, v23
    v_lshlrev_b32 v28, 4, v28
    v_add_u32 v28, 147552, v28
    v_mul_u32_u24 v16, 384, v24
    v_bfe_u32 v17, v24, 1, 2
    v_lshlrev_b32 v17, 5, v17
    s_mul_i32 s10, s3, 96
    v_lshlrev_b32 v21, 4, v23
    v_add_u32 v21, 147712, v21
    v_mov_b32 v29, 148032
    v_cmp_eq_u32 vcc, 0, v22
    v_add_u32 v120, s10, v20
    v_xor_b32 v120, v120, v17
    v_add_u32 v120, v120, v16
    s_add_u32 s10, s10, 24
    v_cndmask_b32 v124, v29, v21, vcc
    v_cmp_eq_u32 vcc, 4, v22
    v_add_u32 v121, s10, v20
    v_xor_b32 v121, v121, v17
    v_add_u32 v121, v121, v16
    s_add_u32 s10, s10, 24
    v_cndmask_b32 v125, v29, v21, vcc
    v_cmp_eq_u32 vcc, 8, v22
    v_add_u32 v122, s10, v20
    v_xor_b32 v122, v122, v17
    v_add_u32 v122, v122, v16
    s_add_u32 s10, s10, 24
    v_cndmask_b32 v126, v29, v21, vcc
    v_cmp_eq_u32 vcc, 12, v22
    v_add_u32 v123, s10, v20
    v_xor_b32 v123, v123, v17
    v_add_u32 v123, v123, v16
    s_add_u32 s10, s10, 24
    v_cndmask_b32 v127, v29, v21, vcc
    s_lshl_b32 s10, s57, 2
    s_add_u32 s10, s10, s3
    s_mul_i32 s11, s10, 96
    s_lshl_b32 s10, s10, 9
    s_add_u32 s10, s10, 294912
    v_lshlrev_b32 v30, 7, v23
    v_lshl_add_u32 v30, v22, 2, v30
    v_add_u32 v30, s10, v30
    v_mul_u32_u24 v31, 24, v23
    v_lshl_add_u32 v31, v22, 1, v31
    v_add_u32 v31, s11, v31
    s_mov_b32 s40, s16
    s_mov_b32 s41, s17
    s_mov_b32 s42, 1152
    s_mov_b32 s43, 0x20000
    s_mov_b32 s44, s34
    s_mov_b32 s45, s35
    s_mov_b32 s46, 1152
    s_mov_b32 s47, 0x20000
    buffer_load_ushort v136, v31, s[40:43], 0 offen
    v_cmp_eq_u32 s[50:51], 12, v22
L_w67:
    ds_read_b32 v4, v2 offset:76
    s_waitcnt lgkmcnt(0)
    v_cmp_le_u32 vcc, 1, v4
    s_cbranch_vccnz L_d68
    s_sub_u32 s56, s56, 1
    s_cbranch_scc1 L_end
    s_sleep 1
    s_branch L_w67
L_d68:
    v_readfirstlane_b32 s55, v4
L_w69:
    ds_read_b32 v4, v2 offset:20
    s_waitcnt lgkmcnt(0)
    v_cmp_le_u32 vcc, 4, v4
    s_cbranch_vccnz L_d70
    s_sub_u32 s56, s56, 1
    s_cbranch_scc1 L_end
    s_branch L_w69
L_d70:
    ds_read_b128 v[32:35], v19 offset:0
    ds_read_b128 v[36:39], v19 offset:1024
    ds_read_b128 v[40:43], v19 offset:2048
    ds_read_b128 v[44:47], v19 offset:3072
    ds_read_b128 v[48:51], v19 offset:4096
    ds_read_b128 v[52:55], v19 offset:5120
    ds_read_b128 v[56:59], v19 offset:6144
    ds_read_b128 v[60:63], v19 offset:7168
    ds_read_b128 v[64:67], v28
    ds_read_b128 v[68:71], v28 offset:32
    v_mov_b32 v132, 0
    v_mov_b32 v133, 0
    v_mov_b32 v134, 0
    v_mov_b32 v135, 0
    v_and_b32 v29, 2, v1
    v_cmp_ne_u32 vcc, 0, v29
    s_waitcnt lgkmcnt(0)
    v_max3_f32 v64, v64, v65, v66
    v_max_f32 v64, v64, v67
    v_add_f32 v68, v68, v69
    v_add_f32 v70, v70, v71
    v_add_f32 v68, v68, v70
    v_mul_f32 v64, 0x3fb8aa3b, v64
    v_mov_b32 v131, s9
    v_cndmask_b32 v130, v64, v68, vcc
    v_cmp_eq_u32 s[10:11], 1, v23
    v_cmp_eq_u32 s[12:13], 2, v23
    v_cmp_eq_u32 s[14:15], 3, v23
L_w71:
    ds_read_b32 v4, v2 offset:24
    s_waitcnt lgkmcnt(0)
    v_cmp_le_u32 vcc, 4, v4
    s_cbranch_vccnz L_d72
    s_sub_u32 s56, s56, 1
    s_cbranch_scc1 L_end
    s_sleep 1
    s_branch L_w71
L_d72:
    ds_read_b64_tr_b16 v[64:65], v25 offset:0
    ds_read_b64_tr_b16 v[66:67], v25 offset:4096
    ds_read_b64_tr_b16 v[96:97], v26 offset:0
    ds_read_b64_tr_b16 v[98:99], v26 offset:4096
    ds_read_b64_tr_b16 v[68:69], v25 offset:8192
    ds_read_b64_tr_b16 v[70:71], v25 offset:12288
    ds_read_b64_tr_b16 v[100:101], v26 offset:8192
    ds_read_b64_tr_b16 v[102:103], v26 offset:12288
    ds_read_b64_tr_b16 v[72:73], v25 offset:16384
    ds_read_b64_tr_b16 v[74:75], v25 offset:20480
    ds_read_b64_tr_b16 v[104:105], v26 offset:16384
    ds_read_b64_tr_b16 v[106:107], v26 offset:20480
    ds_read_b64_tr_b16 v[76:77], v25 offset:24576
    ds_read_b64_tr_b16 v[78:79], v25 offset:28672
    ds_read_b64_tr_b16 v[108:109], v26 offset:24576
    ds_read_b64_tr_b16 v[110:111], v26 offset:28672
    s_waitcnt lgkmcnt(12)
    v_mfma_f32_16x16x32_bf16 v[8:11], v[32:35], v[64:67], 0
    v_mfma_f32_16x16x32_bf16 v[12:15], v[32:35], v[96:99], 0
    s_waitcnt lgkmcnt(8)
    v_mfma_f32_16x16x32_bf16 v[8:11], v[36:39], v[68:71], v[8:11]
    v_mfma_f32_16x16x32_bf16 v[12:15], v[36:39], v[100:103], v[12:15]
    s_waitcnt lgkmcnt(4)
    v_mfma_f32_16x16x32_bf16 v[8:11], v[40:43], v[72:75], v[8:11]
    v_mfma_f32_16x16x32_bf16 v[12:15], v[40:43], v[104:107], v[12:15]
    s_waitcnt lgkmcnt(0)
    v_mfma_f32_16x16x32_bf16 v[8:11], v[44:47], v[76:79], v[8:11]
    v_mfma_f32_16x16x32_bf16 v[12:15], v[44:47], v[108:111], v[12:15]
L_w73:
    ds_read_b32 v4, v2 offset:32
    s_waitcnt lgkmcnt(0)
    v_cmp_le_u32 vcc, 4, v4
    s_cbranch_vccnz L_d74
    s_sub_u32 s56, s56, 1
    s_cbranch_scc1 L_end
    s_branch L_w73
L_d74:
    ds_read_b64_tr_b16 v[64:65], v25 offset:32768
    ds_read_b64_tr_b16 v[66:67], v25 offset:36864
    ds_read_b64_tr_b16 v[96:97], v26 offset:32768
    ds_read_b64_tr_b16 v[98:99], v26 offset:36864
    ds_read_b64_tr_b16 v[68:69], v25 offset:40960
    ds_read_b64_tr_b16 v[70:71], v25 offset:45056
    ds_read_b64_tr_b16 v[100:101], v26 offset:40960
    ds_read_b64_tr_b16 v[102:103], v26 offset:45056
    s_waitcnt lgkmcnt(4)
    v_mfma_f32_16x16x32_bf16 v[8:11], v[48:51], v[64:67], v[8:11]
    v_mfma_f32_16x16x32_bf16 v[12:15], v[48:51], v[96:99], v[12:15]
    s_waitcnt lgkmcnt(0)
    v_mfma_f32_16x16x32_bf16 v[8:11], v[52:55], v[68:71], v[8:11]
    v_mfma_f32_16x16x32_bf16 v[12:15], v[52:55], v[100:103], v[12:15]
L_w75:
    ds_read_b32 v4, v2 offset:36
    s_waitcnt lgkmcnt(0)
    v_cmp_le_u32 vcc, 4, v4
    s_cbranch_vccnz L_d76
    s_sub_u32 s56, s56, 1
    s_cbranch_scc1 L_end
    s_branch L_w75
L_d76:
    ds_read_b64_tr_b16 v[72:73], v25 offset:49152
    ds_read_b64_tr_b16 v[74:75], v25 offset:53248
    ds_read_b64_tr_b16 v[104:105], v26 offset:49152
    ds_read_b64_tr_b16 v[106:107], v26 offset:53248
    s_waitcnt lgkmcnt(0)
    v_mfma_f32_16x16x32_bf16 v[8:11], v[56:59], v[72:75], v[8:11]
    v_mfma_f32_16x16x32_bf16 v[12:15], v[56:59], v[104:107], v[12:15]
L_w77:
    ds_read_b32 v4, v2 offset:28
    s_waitcnt lgkmcnt(0)
    v_cmp_le_u32 vcc, 4, v4
    s_cbranch_vccnz L_d78
    s_sub_u32 s56, s56, 1
    s_cbranch_scc1 L_end
    s_branch L_w77
L_d78:
    ds_read_b64_tr_b16 v[76:77], v25 offset:57344
    ds_read_b64_tr_b16 v[78:79], v25 offset:61440
    ds_read_b64_tr_b16 v[108:109], v26 offset:57344
    ds_read_b64_tr_b16 v[110:111], v26 offset:61440
    s_waitcnt lgkmcnt(0)
    v_mfma_f32_16x16x32_bf16 v[8:11], v[60:63], v[76:79], v[8:11]
    v_mfma_f32_16x16x32_bf16 v[12:15], v[60:63], v[108:111], v[12:15]
    s_nop 6
    v_cndmask_b32 v128, v8, v9, s[10:11]
    v_cndmask_b32 v128, v128, v12, s[12:13]
    v_cndmask_b32 v128, v128, v13, s[14:15]
    s_mov_b32 s10, 0x55555555
    s_mov_b32 s11, s10
    v_mov_b32_dpp v129, v128 quad_perm:[1,1,3,3] row_mask:0xf bank_mask:0xf
    s_mov_b64 exec, s[10:11]
    s_cmp_eq_u32 s55, 1
    s_cbranch_scc1 L_m79
    buffer_store_dwordx4 v[128:131], v27, s[92:95], 0 offen sc1
    s_branch L_m80
L_m79:
    buffer_store_dwordx4 v[128:131], v27, s[92:95], 0 offen
L_m80:
    s_mov_b64 exec, 1
    ds_add_u32 v2, v3 offset:64
    s_mov_b64 exec, -1
    s_cmp_eq_u32 s7, 15
    s_cbranch_scc1 L_Cdone
    s_cmp_eq_u32 s58, 0
    s_cbranch_scc1 L_nowd
L_w81:
    ds_read_b32 v4, v2 offset:40
    s_waitcnt lgkmcnt(0)
    v_cmp_le_u32 vcc, 4, v4
    s_cbranch_vccnz L_d82
    s_sub_u32 s56, s56, 1
    s_cbranch_scc1 L_end
    s_branch L_w81
L_d82:
    ds_read_b64_tr_b16 v[32:33], v120 offset:0
    ds_read_b64_tr_b16 v[34:35], v120 offset:6144
    ds_read_b64_tr_b16 v[36:37], v120 offset:12288
    ds_read_b64_tr_b16 v[38:39], v120 offset:18432
    ds_read_b64_tr_b16 v[40:41], v121 offset:0
    ds_read_b64_tr_b16 v[42:43], v121 offset:6144
    ds_read_b64_tr_b16 v[44:45], v121 offset:12288
    ds_read_b64_tr_b16 v[46:47], v121 offset:18432
    ds_read_b64_tr_b16 v[48:49], v122 offset:0
    ds_read_b64_tr_b16 v[50:51], v122 offset:6144
    ds_read_b64_tr_b16 v[52:53], v122 offset:12288
    ds_read_b64_tr_b16 v[54:55], v122 offset:18432
    ds_read_b64_tr_b16 v[56:57], v123 offset:0
    ds_read_b64_tr_b16 v[58:59], v123 offset:6144
    ds_read_b64_tr_b16 v[60:61], v123 offset:12288
    ds_read_b64_tr_b16 v[62:63], v123 offset:18432
L_w83:
    ds_read_b32 v4, v2 offset:48
    ds_read_b128 v[64:67], v124 offset:0
    ds_read_b128 v[68:71], v124 offset:64
    ds_read_b128 v[72:75], v125 offset:0
    ds_read_b128 v[76:79], v125 offset:64
    ds_read_b128 v[80:83], v126 offset:0
    ds_read_b128 v[84:87], v126 offset:64
    ds_read_b128 v[88:91], v127 offset:0
    ds_read_b128 v[92:95], v127 offset:64
    s_waitcnt lgkmcnt(0)
    v_cmp_le_u32 vcc, 1, v4
    s_cbranch_vccnz L_d84
    s_sub_u32 s56, s56, 1
    s_cbranch_scc1 L_end
    s_branch L_w83
L_d84:
    v_mfma_f32_16x16x32_bf16 v[132:135], v[64:67], v[32:35], v[132:135]
    v_mfma_f32_16x16x32_bf16 v[132:135], v[68:71], v[36:39], v[132:135]
    v_mfma_f32_16x16x32_bf16 v[132:135], v[72:75], v[40:43], v[132:135]
    v_mfma_f32_16x16x32_bf16 v[132:135], v[76:79], v[44:47], v[132:135]
    v_mfma_f32_16x16x32_bf16 v[132:135], v[80:83], v[48:51], v[132:135]
    v_mfma_f32_16x16x32_bf16 v[132:135], v[84:87], v[52:55], v[132:135]
    v_mfma_f32_16x16x32_bf16 v[132:135], v[88:91], v[56:59], v[132:135]
    v_mfma_f32_16x16x32_bf16 v[132:135], v[92:95], v[60:63], v[132:135]
L_nowd:
    s_waitcnt vmcnt(0)
    v_lshlrev_b32 v136, 16, v136
L_w85:
    ds_read_b32 v4, v2 offset:44
    s_waitcnt lgkmcnt(0)
    v_cmp_le_u32 vcc, 4, v4
    s_cbranch_vccnz L_d86
    s_sub_u32 s56, s56, 1
    s_cbranch_scc1 L_end
    s_branch L_w85
L_d86:
    ds_read_b64_tr_b16 v[32:33], v120 offset:24576
    ds_read_b64_tr_b16 v[34:35], v120 offset:30720
    ds_read_b64_tr_b16 v[36:37], v120 offset:36864
    ds_read_b64_tr_b16 v[38:39], v120 offset:43008
    ds_read_b64_tr_b16 v[40:41], v121 offset:24576
    ds_read_b64_tr_b16 v[42:43], v121 offset:30720
    ds_read_b64_tr_b16 v[44:45], v121 offset:36864
    ds_read_b64_tr_b16 v[46:47], v121 offset:43008
    ds_read_b64_tr_b16 v[48:49], v122 offset:24576
    ds_read_b64_tr_b16 v[50:51], v122 offset:30720
    ds_read_b64_tr_b16 v[52:53], v122 offset:36864
    ds_read_b64_tr_b16 v[54:55], v122 offset:43008
    ds_read_b64_tr_b16 v[56:57], v123 offset:24576
    ds_read_b64_tr_b16 v[58:59], v123 offset:30720
    ds_read_b64_tr_b16 v[60:61], v123 offset:36864
    ds_read_b64_tr_b16 v[62:63], v123 offset:43008
L_w87:
    ds_read_b32 v4, v2 offset:52
    ds_read_b128 v[64:67], v124 offset:128
    ds_read_b128 v[68:71], v124 offset:192
    ds_read_b128 v[72:75], v125 offset:128
    ds_read_b128 v[76:79], v125 offset:192
    ds_read_b128 v[80:83], v126 offset:128
    ds_read_b128 v[84:87], v126 offset:192
    ds_read_b128 v[88:91], v127 offset:128
    ds_read_b128 v[92:95], v127 offset:192
    s_waitcnt lgkmcnt(0)
    v_cmp_le_u32 vcc, 4, v4
    s_cbranch_vccnz L_d88
    s_sub_u32 s56, s56, 1
    s_cbranch_scc1 L_end
    s_branch L_w87
L_d88:
    v_mfma_f32_16x16x32_bf16 v[132:135], v[64:67], v[32:35], v[132:135]
    v_mfma_f32_16x16x32_bf16 v[8:11], v[80:83], v[48:51], 0
    v_mfma_f32_16x16x32_bf16 v[132:135], v[72:75], v[40:43], v[132:135]
    v_mfma_f32_16x16x32_bf16 v[8:11], v[88:91], v[56:59], v[8:11]
    v_mfma_f32_16x16x32_bf16 v[132:135], v[68:71], v[36:39], v[132:135]
    v_mfma_f32_16x16x32_bf16 v[8:11], v[84:87], v[52:55], v[8:11]
    v_mfma_f32_16x16x32_bf16 v[132:135], v[76:79], v[44:47], v[132:135]
    v_mfma_f32_16x16x32_bf16 v[8:11], v[92:95], v[60:63], v[8:11]
    s_mov_b32 exec_lo, 0x1fff1fff
    s_mov_b32 exec_hi, 0x1fff1fff
    s_nop 5
    v_add_f32 v132, v132, v8
    v_cndmask_b32 v132, v132, 1.0, s[50:51]
    v_add_f32 v136, v136, v132
    buffer_atomic_add_f32 v132, v30, s[92:95], 0 offen sc0
    s_waitcnt vmcnt(0)
    v_cmp_eq_f32 vcc, 0x429e0000, v132
    v_add_f32 v136, v136, v132
    s_lshr_b64 s[10:11], vcc, 12
    s_and_b32 s10, s10, 0x00010001
    s_and_b32 s11, s11, 0x00010001
    v_cvt_pk_bf16_f32 v136, v136, v136
    s_lshl_b64 s[12:13], s[10:11], 12
    s_sub_u32 s12, s12, s10
    s_subb_u32 s13, s13, s11
    s_mov_b64 exec, s[12:13]
    s_cbranch_execz L_Cdone
    buffer_store_short v136, v31, s[44:47], 0 offen
    s_or_b32 s12, s57, s3
    s_andn2_b32 s10, 1, s10
    s_or_b32 s10, s10, s12
    s_cbranch_scc1 L_Cdone
    s_mov_b64 exec, 1
    v_mov_b32 v8, 0
    v_mov_b32 v9, s9
    buffer_store_dword v9, v8, s[92:95], 0 offen sc1
L_Cdone:
    s_endpgm
L_X:
    s_setprio 3
    s_cmp_lg_u32 s3, 8
    s_cbranch_scc1 L_Xo
    s_waitcnt vmcnt(0)
    v_readfirstlane_b32 s9, v21
    s_nop 0
    s_mul_i32 s9, s9, 1664525
    s_add_u32 s9, s9, 1013904223
    s_lshl_b32 s10, s6, 13
    s_add_u32 s10, s10, 4096
    v_add_u32 v14, s10, v5
    v_add_u32 v15, 0x1000, v14
    v_and_b32 v10, 31, v1
    v_lshlrev_b32 v10, 1, v10
    v_and_b32 v6, 7, v10
    v_lshlrev_b32 v6, 3, v6
    v_bfe_u32 v11, v10, 3, 1
    v_lshl_add_u32 v6, v11, 2, v6
    v_bfe_u32 v11, v10, 4, 1
    v_lshl_add_u32 v6, v11, 1, v6
    v_bfe_u32 v11, v10, 5, 1
    v_add_u32 v6, v11, v6
    v_lshrrev_b32 v11, 5, v1
    v_lshl_add_u32 v6, v11, 6, v6
    v_lshlrev_b32 v6, 1, v6
    v_add_u32 v6, 138240, v6
    v_and_b32 v7, 7, v1
    v_lshlrev_b32 v7, 3, v7
    v_bfe_u32 v11, v1, 3, 1
    v_lshl_add_u32 v7, v11, 2, v7
    v_bfe_u32 v11, v1, 4, 1
    v_lshl_add_u32 v7, v11, 1, v7
    v_bfe_u32 v11, v1, 5, 1
    v_add_u32 v7, v11, v7
    v_lshrrev_b32 v10, 5, v7
    v_lshlrev_b32 v10, 6, v10
    v_bfe_u32 v11, v7, 2, 2
    v_lshl_add_u32 v10, v11, 4, v10
    v_bfe_u32 v11, v7, 4, 1
    v_lshl_add_u32 v10, v11, 3, v10
    v_and_b32 v11, 3, v7
    v_lshl_add_u32 v10, v11, 1, v10
    v_add_u32 v7, 147712, v10
    s_cmp_ge_u32 s2, 48
    s_cbranch_scc1 L_noinit
    v_cmp_eq_u32 vcc, 14, v1
    s_lshl_b32 s10, s2, 7
    s_add_u32 s10, s10, 294912
    v_mov_b32 v10, s9
    v_lshlrev_b32 v11, 2, v1
    v_add_u32 v11, s10, v11
    v_cndmask_b32 v10, 0, v10, vcc
    s_mov_b64 exec, 0xffff
    buffer_store_dword v10, v11, s[92:95], 0 offen sc1
    s_mov_b64 exec, -1
L_noinit:
    s_lshl_b32 s10, s57, 11
    s_add_u32 s10, s10, 294968
    v_and_b32 v16, 15, v1
    v_lshlrev_b32 v16, 7, v16
    v_add_u32 v16, s10, v16
    s_getreg_b32 s12, hwreg(HW_REG_XCC_ID, 0, 4)
    s_andn2_b32 s13, s9, 15
    s_or_b32 s12, s12, s13
L_w89:
    ds_read_b32 v4, v2 offset:56
    s_waitcnt lgkmcnt(0)
    v_cmp_le_u32 vcc, 1, v4
    s_cbranch_vccnz L_d90
    s_sub_u32 s56, s56, 1
    s_cbranch_scc1 L_end
    s_sleep 1
    s_branch L_w89
L_d90:
L_w91:
    ds_read_b32 v4, v2 offset:4
    s_waitcnt lgkmcnt(0)
    v_cmp_le_u32 vcc, 4, v4
    s_cbranch_vccnz L_d92
    s_sub_u32 s56, s56, 1
    s_cbranch_scc1 L_end
    s_sleep 1
    s_branch L_w91
L_d92:
    v_add_u32 v12, 131072, v14
    v_add_u32 v13, 131072, v15
    s_mov_b32 s15, 0
L_gq:
    s_cmp_lt_u32 s15, 4
    s_cbranch_scc1 L_gqA
    s_bitcmp1_b32 s15, 0
    s_cbranch_scc1 L_gqA
    buffer_load_dwordx4 v[24:27], v12, s[92:95], 0 offen offset:0 sc1
    buffer_load_dwordx4 v[28:31], v12, s[92:95], 0 offen offset:1024 sc1
    buffer_load_dwordx4 v[32:35], v12, s[92:95], 0 offen offset:2048 sc1
    buffer_load_dwordx4 v[36:39], v12, s[92:95], 0 offen offset:3072 sc1
    buffer_load_dwordx4 v[40:43], v13, s[92:95], 0 offen offset:0 sc1
    buffer_load_dwordx4 v[44:47], v13, s[92:95], 0 offen offset:1024 sc1
    buffer_load_dwordx4 v[48:51], v13, s[92:95], 0 offen offset:2048 sc1
    buffer_load_dwordx4 v[52:55], v13, s[92:95], 0 offen offset:3072 sc1
    s_branch L_gqW
L_gqA:
    buffer_load_dwordx4 v[24:27], v14, s[92:95], 0 offen offset:0 nt
    buffer_load_dwordx4 v[28:31], v14, s[92:95], 0 offen offset:1024 nt
    buffer_load_dwordx4 v[32:35], v14, s[92:95], 0 offen offset:2048 nt
    buffer_load_dwordx4 v[36:39], v14, s[92:95], 0 offen offset:3072 nt
    buffer_load_dwordx4 v[40:43], v15, s[92:95], 0 offen offset:0 nt
    buffer_load_dwordx4 v[44:47], v15, s[92:95], 0 offen offset:1024 nt
    buffer_load_dwordx4 v[48:51], v15, s[92:95], 0 offen offset:2048 nt
    buffer_load_dwordx4 v[52:55], v15, s[92:95], 0 offen offset:3072 nt
L_gqW:
    buffer_load_dword v17, v16, s[92:95], 0 offen sc1
    s_waitcnt vmcnt(0)
    v_xor_b32 v8, s12, v25
    v_xor_b32 v9, s12, v27
    v_or_b32 v8, v8, v9
    v_xor_b32 v9, s12, v29
    v_or_b32 v8, v8, v9
    v_xor_b32 v9, s12, v31
    v_or_b32 v8, v8, v9
    v_xor_b32 v9, s12, v33
    v_or_b32 v8, v8, v9
    v_xor_b32 v9, s12, v35
    v_or_b32 v8, v8, v9
    v_xor_b32 v9, s12, v37
    v_or_b32 v8, v8, v9
    v_xor_b32 v9, s12, v39
    v_or_b32 v8, v8, v9
    v_xor_b32 v9, s12, v41
    v_or_b32 v8, v8, v9
    v_xor_b32 v9, s12, v43
    v_or_b32 v8, v8, v9
    v_xor_b32 v9, s12, v45
    v_or_b32 v8, v8, v9
    v_xor_b32 v9, s12, v47
    v_or_b32 v8, v8, v9
    v_xor_b32 v9, s12, v49
    v_or_b32 v8, v8, v9
    v_xor_b32 v9, s12, v51
    v_or_b32 v8, v8, v9
    v_xor_b32 v9, s12, v53
    v_or_b32 v8, v8, v9
    v_xor_b32 v9, s12, v55
    v_or_b32 v8, v8, v9
    v_cmp_ne_u32 s[10:11], s9, v17
    v_cmp_lt_u32 vcc, 15, v8
    s_or_b64 vcc, vcc, s[10:11]
    s_cbranch_scc0 L_gq_ok
    s_sub_u32 s56, s56, 1
    s_cbranch_scc1 L_end
    s_add_u32 s15, s15, 1
    s_cmp_lg_u32 s15, 4
    s_cbranch_scc1 L_gq
    v_lshlrev_b32 v18, 3, v1
    v_add_u32 v19, 138752, v18
    ds_read_b64 v[20:21], v19
    s_lshl_b32 s10, s6, 13
    s_lshl_b32 s11, s7, 9
    s_add_u32 s10, s10, s11
    s_add_u32 s10, s10, 135168
    v_add_u32 v18, s10, v18
    s_waitcnt lgkmcnt(0)
    buffer_store_dwordx2 v[20:21], v18, s[92:95], 0 offen sc1
    s_branch L_gq
L_gq_ok:
    v_cmp_ne_u32 vcc, 0, v8
    s_cmp_eq_u64 vcc, 0
    s_cselect_b32 s55, 1, 2
    s_cbranch_scc1 L_gq_m
    s_cmp_ge_u32 s15, 4
    s_cbranch_scc1 L_gq_m
    v_lshlrev_b32 v18, 3, v1
    v_add_u32 v19, 138752, v18
    ds_read_b64 v[20:21], v19
    s_lshl_b32 s10, s6, 13
    s_lshl_b32 s11, s7, 9
    s_add_u32 s10, s10, s11
    s_add_u32 s10, s10, 135168
    v_add_u32 v18, s10, v18
    s_waitcnt lgkmcnt(0)
    buffer_store_dwordx2 v[20:21], v18, s[92:95], 0 offen sc1
L_gq_m:
    v_mov_b32 v10, s55
    v_mov_b32 v11, s9
    s_mov_b64 exec, 1
    ds_write_b32 v2, v11 offset:84
    ds_write_b32 v2, v10 offset:76
    s_mov_b64 exec, -1
    v_add_f32 v24, v24, v32
    v_add_f32 v40, v40, v48
    v_add_f32 v24, v24, v40
    v_add_f32 v26, v26, v34
    v_add_f32 v42, v42, v50
    v_add_f32 v26, v26, v42
    v_add_f32 v28, v28, v36
    v_add_f32 v44, v44, v52
    v_add_f32 v28, v28, v44
    v_add_f32 v30, v30, v38
    v_add_f32 v46, v46, v54
    v_add_f32 v30, v30, v46
    v_cvt_pk_bf16_f32 v24, v24, v26
    ds_write_b16 v6, v24 offset:0
    ds_write_b16_d16_hi v6, v24 offset:16
    v_cvt_pk_bf16_f32 v28, v28, v30
    ds_write_b16 v6, v28 offset:256
    ds_write_b16_d16_hi v6, v28 offset:272
    s_mov_b64 exec, 1
    ds_add_u32 v2, v3 offset:8
    s_mov_b64 exec, -1
    s_cmp_eq_u32 s58, 0
    s_cbranch_scc1 L_noh
    s_lshl_b32 s10, s8, 14
    s_add_u32 s10, s10, 1179648
    v_add_u32 v14, s10, v5
    v_add_u32 v15, 0x1000, v14
    v_add_u32 v16, 0x2000, v14
L_w93:
    ds_read_b32 v4, v2 offset:60
    s_waitcnt lgkmcnt(0)
    v_cmp_le_u32 vcc, 1, v4
    s_cbranch_vccnz L_d94
    s_sub_u32 s56, s56, 1
    s_cbranch_scc1 L_end
    s_sleep 1
    s_branch L_w93
L_d94:
L_w95:
    ds_read_b32 v4, v2 offset:20
    s_waitcnt lgkmcnt(0)
    v_cmp_le_u32 vcc, 4, v4
    s_cbranch_vccnz L_d96
    s_sub_u32 s56, s56, 1
    s_cbranch_scc1 L_end
    s_sleep 1
    s_branch L_w95
L_d96:
L_gh:
    s_cmp_eq_u32 s55, 1
    s_cbranch_scc1 L_m97
    buffer_load_dwordx4 v[24:27], v14, s[92:95], 0 offen offset:0 sc1
    buffer_load_dwordx4 v[28:31], v14, s[92:95], 0 offen offset:1024 sc1
    buffer_load_dwordx4 v[32:35], v14, s[92:95], 0 offen offset:2048 sc1
    s_branch L_m98
L_m97:
    buffer_load_dwordx4 v[24:27], v14, s[92:95], 0 offen offset:0 nt
    buffer_load_dwordx4 v[28:31], v14, s[92:95], 0 offen offset:1024 nt
    buffer_load_dwordx4 v[32:35], v14, s[92:95], 0 offen offset:2048 nt
L_m98:
    s_waitcnt vmcnt(0)
    v_xor_b32 v8, s9, v26
    v_xor_b32 v9, s9, v30
    v_or_b32 v8, v8, v9
    v_xor_b32 v9, s9, v34
    v_or_b32 v8, v8, v9
    v_cmp_lt_u32 vcc, 0, v8
    s_cbranch_vccz L_t99
    s_sub_u32 s56, s56, 1
    s_cbranch_scc1 L_end
    s_branch L_gh
L_t99:
    v_add_f32 v24, v24, v28
    v_add_f32 v25, v25, v29
    v_add_f32 v24, v24, v32
    v_add_f32 v25, v25, v33
    v_cvt_pk_bf16_f32 v24, v24, v25
    v_and_b32 v25, 0xffff0000, v24
    v_lshlrev_b32 v24, 16, v24
    v_mul_f32 v26, 0xbfb8aa3b, v24
    v_exp_f32 v26, v26
    s_nop 0
    v_add_f32 v26, 1.0, v26
    v_rcp_f32 v26, v26
    s_nop 0
    v_mul_f32 v24, v24, v26
    v_cvt_pk_bf16_f32 v24, v24, v24
    v_and_b32 v24, 0xffff0000, v24
    v_mul_f32 v24, v24, v25
    v_cvt_pk_bf16_f32 v24, v24, v24
    ds_write_b16 v7, v24
    s_mov_b64 exec, 1
    ds_add_u32 v2, v3 offset:48
    s_mov_b64 exec, -1
L_noh:
    s_mov_b32 s14, 3
    s_cmp_eq_u32 s59, 0
    s_cbranch_scc1 L_Xo2
    s_mov_b64 exec, 1
    ds_add_u32 v2, v3 offset:52
    s_mov_b64 exec, -1
    s_endpgm
L_Xo:
    s_cmp_eq_u32 s7, 15
    s_cbranch_scc1 L_end
    s_sub_u32 s14, s3, 9
L_w100:
    ds_read_b32 v4, v2 offset:76
    ds_read_b32 v10, v2 offset:84
    s_waitcnt lgkmcnt(0)
    v_cmp_le_u32 vcc, 1, v4
    s_cbranch_vccnz L_d101
    s_sub_u32 s56, s56, 1
    s_cbranch_scc1 L_end
    s_sleep 1
    s_branch L_w100
L_d101:
    v_readfirstlane_b32 s55, v4
    v_readfirstlane_b32 s9, v10
L_Xo2:
    v_and_b32 v10, 1, v1
    v_cmp_ne_u32 vcc, 0, v10
    s_mov_b64 s[12:13], vcc
    v_lshrrev_b32 v7, 1, v1
    v_lshlrev_b32 v7, 4, v7
    v_lshl_add_u32 v7, v10, 2, v7
    s_lshr_b32 s10, s14, 1
    s_lshl_b32 s10, s10, 6
    s_and_b32 s11, s14, 1
    s_lshl_b32 s11, s11, 3
    s_add_u32 s10, s10, s11
    s_add_u32 s10, s10, 147840
    v_add_u32 v6, s10, v7
    s_mul_i32 s10, s14, 5
    s_add_u32 s10, s10, s59
    s_lshl_b32 s11, s6, 4
    s_add_u32 s10, s10, s11
    s_lshl_b32 s10, s10, 11
    s_add_u32 s10, s10, 655360
    v_add_u32 v14, s10, v5
L_w102:
    ds_read_b32 v4, v2 offset:64
    s_waitcnt lgkmcnt(0)
    v_cmp_le_u32 vcc, 4, v4
    s_cbranch_vccnz L_d103
    s_sub_u32 s56, s56, 1
    s_cbranch_scc1 L_end
    s_sleep 1
    s_branch L_w102
L_d103:
L_go:
    s_cmp_eq_u32 s55, 1
    s_cbranch_scc1 L_m104
    buffer_load_dwordx4 v[24:27], v14, s[92:95], 0 offen offset:0 sc1
    buffer_load_dwordx4 v[28:31], v14, s[92:95], 0 offen offset:1024 sc1
    s_branch L_m105
L_m104:
    buffer_load_dwordx4 v[24:27], v14, s[92:95], 0 offen offset:0 nt
    buffer_load_dwordx4 v[28:31], v14, s[92:95], 0 offen offset:1024 nt
L_m105:
    s_waitcnt vmcnt(0)
    v_xor_b32 v8, s9, v27
    v_xor_b32 v9, s9, v31
    v_or_b32 v8, v8, v9
    v_cmp_lt_u32 vcc, 0, v8
    s_cbranch_vccz L_t106
    s_sub_u32 s56, s56, 1
    s_cbranch_scc1 L_end
    s_branch L_go
L_t106:
    v_mov_b32_dpp v27, v26 quad_perm:[1,0,3,2] row_mask:0xf bank_mask:0xf
    v_mov_b32_dpp v31, v30 quad_perm:[1,0,3,2] row_mask:0xf bank_mask:0xf
    v_cndmask_b32 v10, v26, v27, s[12:13]
    v_cndmask_b32 v26, v27, v26, s[12:13]
    v_cndmask_b32 v11, v30, v31, s[12:13]
    v_cndmask_b32 v30, v31, v30, s[12:13]
    v_max_f32 v8, v10, v11
    s_nop 1
    v_max_f32_dpp v8, v8, v8 row_ror:8 row_mask:0xf bank_mask:0xf
    v_mov_b32 v9, v8
    s_nop 1
    v_permlane32_swap_b32 v8, v9
    v_max_f32 v8, v8, v9
    v_mov_b32 v9, v8
    s_nop 1
    v_permlane16_swap_b32 v8, v9
    v_max_f32 v8, v8, v9
    v_sub_f32 v10, v10, v8
    v_sub_f32 v11, v11, v8
    v_exp_f32 v10, v10
    v_exp_f32 v11, v11
    v_mul_f32 v24, v24, v10
    v_mul_f32 v25, v25, v10
    v_mul_f32 v26, v26, v10
    v_fmac_f32 v24, v28, v11
    v_fmac_f32 v25, v29, v11
    v_fmac_f32 v26, v30, v11
    v_add_f32_dpp v24, v24, v24 row_ror:8 row_mask:0xf bank_mask:0xf
    v_add_f32_dpp v25, v25, v25 row_ror:8 row_mask:0xf bank_mask:0xf
    v_add_f32_dpp v26, v26, v26 row_ror:8 row_mask:0xf bank_mask:0xf
    v_mov_b32 v28, v26
    v_mov_b32 v29, v24
    v_mov_b32 v30, v25
    v_permlane32_swap_b32 v26, v28
    v_permlane32_swap_b32 v24, v29
    v_permlane32_swap_b32 v25, v30
    v_add_f32 v26, v26, v28
    v_add_f32 v24, v24, v29
    v_add_f32 v25, v25, v30
    v_mov_b32 v28, v26
    v_mov_b32 v29, v24
    v_mov_b32 v30, v25
    v_permlane16_swap_b32 v26, v28
    v_permlane16_swap_b32 v24, v29
    v_permlane16_swap_b32 v25, v30
    v_add_f32 v26, v26, v28
    v_add_f32 v24, v24, v29
    v_add_f32 v25, v25, v30
    v_rcp_f32 v26, v26
    s_mov_b64 exec, 0xff
    v_mul_f32 v24, v24, v26
    v_mul_f32 v25, v25, v26
    v_cvt_pk_bf16_f32 v24, v24, v25
    ds_write_b32 v6, v24
    s_mov_b64 exec, 1
    ds_add_u32 v2, v3 offset:52
    s_mov_b64 exec, -1
L_end:
    s_endpgm
L_codeend:
.fill ((13312 - (L_codeend - parallel_sum__sliding_block_cached__swiglu_ffn__decode_kernel)) / 4), 4, 0xbf810000
s_endpgm
.section .rodata,"a"
.p2align 6
.amdhsa_kernel parallel_sum__sliding_block_cached__swiglu_ffn__decode_kernel
  .amdhsa_next_free_vgpr 140
  .amdhsa_next_free_sgpr 96
  .amdhsa_accum_offset 140
  .amdhsa_group_segment_fixed_size 0
  .amdhsa_kernarg_size 96
  .amdhsa_user_sgpr_count 2
  .amdhsa_user_sgpr_kernarg_segment_ptr 1
  .amdhsa_system_sgpr_workgroup_id_x 1
  .amdhsa_float_denorm_mode_32 3
.end_amdhsa_kernel
```
